```python
import torch

def _softmax(x, axis=-1):
    return torch.softmax(x, dim=axis)

def _gelu(x):
    return torch.nn.functional.gelu(x, approximate='tanh')

def _silu(x):
    return torch.nn.functional.silu(x)

def _sigmoid(x):
    return torch.sigmoid(x)

def _layernorm(x, axis=-1, eps=1e-05):
    m = x.mean(dim=axis, keepdim=True)
    v = x.var(dim=axis, keepdim=True, unbiased=False)
    return (x - m) / torch.sqrt(v + eps)

def _scatter_add(tgt, idx, src, axis=0):
    return tgt.clone().index_add_(axis, idx, src)

def _segment_sum(src, seg, n):
    out = torch.zeros((n,) + src.shape[1:], dtype=src.dtype)
    return out.index_add_(0, seg, src)

def _pad(x, pw):
    flat = tuple((v for pair in reversed(pw) for v in pair))
    return torch.nn.functional.pad(x, flat)
kernel_name = 'standalone__tensor_product_equiv_equiformer__graph'

def setup_inputs():

    _w = lambda a: (lambda t: t.to(torch.bfloat16) if t.is_floating_point() else t)(torch.as_tensor(a))
    N, deg, C, De = (25000, 32, 64, max(0, 1))
    E = N * deg
    src = (lambda lo, hi, *s: torch.randint(lo, hi, s))(0, N, E).to(torch.int64)
    dst = (lambda lo, hi, *s: torch.randint(lo, hi, s))(0, N, E).to(torch.int64)
    rvec = (lambda *s: torch.randn(*s, dtype=torch.bfloat16) * 0.05)(E, 3).to(float)
    rn = (torch.linalg.norm(rvec, dim=-1, keepdim=True) + 1e-06).to(float)
    rhat = (rvec / rn).to(float)
    eps = torch.zeros((3, 3, 3), dtype=float)
    eps[0, 1, 2] = eps[1, 2, 0] = eps[2, 0, 1] = 1.0
    eps[0, 2, 1] = eps[2, 1, 0] = eps[1, 0, 2] = -1.0
    return {'x': _w((lambda *s: torch.randn(*s, dtype=torch.bfloat16) * 0.4)(N, 4 * C).to(float)), 'rhat': _w(rhat), 'e_attr': _w((lambda *s: torch.randn(*s, dtype=torch.bfloat16) * 0.4)(E, De).to(float)), 'src': _w(src), 'dst': _w(dst), 'w_rad': _w((lambda *s: torch.randn(*s, dtype=torch.bfloat16) * 0.4)(De, 5 * C).to(float)), 'w_si0': _w((lambda *s: torch.randn(*s, dtype=torch.bfloat16) * 0.4)(2 * C, C).to(float)), 'w_si1': _w((lambda *s: torch.randn(*s, dtype=torch.bfloat16) * 0.05)(3 * C, C).to(float)), 'cg_eps': _w(eps)}

def reference(x, rhat, e_attr, src, dst, w_rad, w_si0, w_si1, cg_eps):
    N = x.shape[0]
    C = w_si0.shape[1]
    E = rhat.shape[0]
    x0 = x[:, :C].clone()
    x1 = x[:, C:].reshape(N, 3, C)
    R = (e_attr @ w_rad).reshape(E, 5, C)
    f0 = x0[src]
    f1 = x1[src]
    Y1 = rhat
    p00_0 = f0 * R[:, 0, :]
    p11_0 = torch.einsum('ejc,ej->ec', f1, Y1) * R[:, 1, :]
    p01_1 = torch.einsum('ec,ej->ejc', f0, Y1) * R[:, 2, :][:, None, :]
    p10_1 = f1 * R[:, 3, :][:, None, :]
    p11_1 = torch.einsum('ijk,ekc,ej->eic', cg_eps, f1, Y1) * R[:, 4, :][:, None, :]
    m0 = torch.concatenate([p00_0, p11_0], axis=-1) @ w_si0
    m1 = torch.einsum('ejp,pc->ejc', torch.concatenate([p01_1, p10_1, p11_1], axis=-1), w_si1)
    agg0 = _segment_sum(m0, dst, N)
    agg1 = _segment_sum(m1.reshape(E, 3 * C), dst, N).reshape(N, 3, C)
    gate = _sigmoid(agg0)
    out1 = agg1 * gate[:, None, :]
    return torch.concatenate([agg0, out1.reshape(N, 3 * C)], axis=-1)
```

```asm
; @launch kernel=part_kernel grid=(256,1,1) block=(832,1,1) lds=40960
; @launch kernel=main_kernel grid=(256,1,1) block=(512,1,1) lds=136704
.amdgcn_target "amdgcn-amd-amdhsa--gfx950"
.text
    .p2align 8
    .globl part_kernel
    .type part_kernel,@function
part_kernel:
    s_cmp_ge_u32 s2, 256
    s_cbranch_scc1 P_done
    s_load_dwordx4 s[4:7], s[0:1], 8
    s_load_dwordx4 s[8:11], s[0:1], 24
    s_load_dwordx4 s[12:15], s[0:1], 40
    s_load_dwordx2 s[16:17], s[0:1], 56
    s_load_dwordx2 s[18:19], s[0:1], 88
    s_load_dwordx2 s[28:29], s[0:1], 0
    s_load_dwordx2 s[30:31], s[0:1], 72
    s_cmp_ge_u32 s2, 250
    s_cbranch_scc1 P_prep
    v_lshlrev_b32 v1, 2, v0
    v_mov_b32 v2, 0
    v_cmp_gt_u32 vcc, 256, v0
    s_and_saveexec_b64 s[20:21], vcc
    ds_write_b32 v1, v2
    s_mov_b64 exec, s[20:21]
    s_mul_i32 s3, s2, 3200
    v_lshl_add_u32 v3, v0, 2, s3
    v_lshlrev_b32 v4, 2, v3
    v_lshlrev_b32 v5, 1, v3
    v_mul_u32_u24 v6, 6, v3
    v_cmp_gt_u32 vcc, 800, v0
    s_and_saveexec_b64 s[20:21], vcc
    s_waitcnt lgkmcnt(0)
    global_load_dwordx4 v[8:11], v4, s[10:11]
    s_barrier
    global_load_dwordx4 v[12:15], v4, s[8:9]
    global_load_dwordx2 v[16:17], v5, s[6:7]
    global_load_dwordx4 v[20:23], v6, s[4:5]
    global_load_dwordx2 v[24:25], v6, s[4:5] offset:16
    v_mov_b32 v2, 1
    s_waitcnt vmcnt(4)
    v_mul_u32_u24 v28, 85599, v8
    v_lshrrev_b32 v28, 23, v28
    v_min_u32 v28, 255, v28
    v_lshlrev_b32 v36, 2, v28
    ds_add_rtn_u32 v32, v36, v2
    v_mul_u32_u24 v29, 85599, v9
    v_lshrrev_b32 v29, 23, v29
    v_min_u32 v29, 255, v29
    v_lshlrev_b32 v37, 2, v29
    ds_add_rtn_u32 v33, v37, v2
    v_mul_u32_u24 v30, 85599, v10
    v_lshrrev_b32 v30, 23, v30
    v_min_u32 v30, 255, v30
    v_lshlrev_b32 v38, 2, v30
    ds_add_rtn_u32 v34, v38, v2
    v_mul_u32_u24 v31, 85599, v11
    v_lshrrev_b32 v31, 23, v31
    v_min_u32 v31, 255, v31
    v_lshlrev_b32 v39, 2, v31
    ds_add_rtn_u32 v35, v39, v2
    s_mov_b64 exec, -1
    s_waitcnt lgkmcnt(0)
    s_barrier
    v_cmp_gt_u32 vcc, 64, v0
    s_cbranch_vccz P_skipscan
    v_lshlrev_b32 v1, 4, v0
    ds_read_b128 v[72:75], v1
    s_waitcnt lgkmcnt(0)
    v_add_u32 v76, v72, v73
    v_add_u32 v77, v76, v74
    v_add_u32 v78, v77, v75
    v_mov_b32 v79, v78
    s_nop 1
    v_add_u32_dpp v79, v79, v79 row_shr:1 row_mask:0xf bank_mask:0xf bound_ctrl:0
    s_nop 1
    v_add_u32_dpp v79, v79, v79 row_shr:2 row_mask:0xf bank_mask:0xf bound_ctrl:0
    s_nop 1
    v_add_u32_dpp v79, v79, v79 row_shr:4 row_mask:0xf bank_mask:0xf bound_ctrl:0
    s_nop 1
    v_add_u32_dpp v79, v79, v79 row_shr:8 row_mask:0xf bank_mask:0xf bound_ctrl:0
    s_nop 1
    v_add_u32_dpp v79, v79, v79 row_bcast:15 row_mask:0xa bank_mask:0xf
    s_nop 1
    v_add_u32_dpp v79, v79, v79 row_bcast:31 row_mask:0xc bank_mask:0xf
    s_nop 1
    v_sub_u32 v80, v79, v78
    v_add_u32 v81, v80, v72
    v_add_u32 v82, v80, v76
    v_add_u32 v83, v80, v77
    ds_write_b128 v1, v[80:83]
    v_lshl_or_b32 v72, v72, 16, v80
    v_lshl_or_b32 v73, v73, 16, v81
    v_lshl_or_b32 v74, v74, 16, v82
    v_lshl_or_b32 v75, v75, 16, v83
    v_mov_b32 v84, v72
    v_mov_b32 v85, v73
    v_mov_b32 v86, v74
    v_mov_b32 v87, v75
    s_waitcnt lgkmcnt(0)
P_skipscan:
    v_cmp_gt_u32 vcc, 800, v0
    s_and_saveexec_b64 s[20:21], vcc
    s_movk_i32 s22, 98
    s_mov_b32 s23, 0xffff0000
    v_mul_u32_u24 v1, s22, v28
    v_sub_u32 v1, v8, v1
    v_and_b32 v1, 127, v1
    v_lshlrev_b32 v8, 21, v1
    v_lshrrev_b32 v72, 5, v28
    v_mul_u32_u24 v1, s22, v29
    v_sub_u32 v1, v9, v1
    v_and_b32 v1, 127, v1
    v_lshlrev_b32 v9, 21, v1
    v_lshrrev_b32 v73, 5, v29
    v_mul_u32_u24 v1, s22, v30
    v_sub_u32 v1, v10, v1
    v_and_b32 v1, 127, v1
    v_lshlrev_b32 v10, 21, v1
    v_lshrrev_b32 v74, 5, v30
    v_mul_u32_u24 v1, s22, v31
    v_sub_u32 v1, v11, v1
    v_and_b32 v1, 127, v1
    v_lshlrev_b32 v11, 21, v1
    v_lshrrev_b32 v75, 5, v31
    s_barrier
    ds_read_b32 v28, v36
    ds_read_b32 v29, v37
    ds_read_b32 v30, v38
    ds_read_b32 v31, v39
    s_waitcnt lgkmcnt(0)
    v_add_u32 v28, v28, v32
    v_mul_u32_u24 v28, 12, v28
    v_add_u32 v28, 1024, v28
    v_add_u32 v29, v29, v33
    v_mul_u32_u24 v29, 12, v29
    v_add_u32 v29, 1024, v29
    v_add_u32 v30, v30, v34
    v_mul_u32_u24 v30, 12, v30
    v_add_u32 v30, 1024, v30
    v_add_u32 v31, v31, v35
    v_mul_u32_u24 v31, 12, v31
    v_add_u32 v31, 1024, v31
    s_waitcnt vmcnt(3)
    v_mul_u32_u24 v4, 85900, v12
    v_lshrrev_b32 v4, 28, v4
    v_min_u32 v4, 7, v4
    v_sub_u32 v4, v4, v72
    v_and_b32 v4, 7, v4
    v_lshl_or_b32 v4, v4, 18, v8
    v_and_b32 v3, 0x7fff, v12
    v_or_b32 v42, v3, v4
    v_mul_u32_u24 v4, 85900, v13
    v_lshrrev_b32 v4, 28, v4
    v_min_u32 v4, 7, v4
    v_sub_u32 v4, v4, v73
    v_and_b32 v4, 7, v4
    v_lshl_or_b32 v4, v4, 18, v9
    v_and_b32 v3, 0x7fff, v13
    v_or_b32 v46, v3, v4
    v_mul_u32_u24 v4, 85900, v14
    v_lshrrev_b32 v4, 28, v4
    v_min_u32 v4, 7, v4
    v_sub_u32 v4, v4, v74
    v_and_b32 v4, 7, v4
    v_lshl_or_b32 v4, v4, 18, v10
    v_and_b32 v3, 0x7fff, v14
    v_or_b32 v50, v3, v4
    v_mul_u32_u24 v4, 85900, v15
    v_lshrrev_b32 v4, 28, v4
    v_min_u32 v4, 7, v4
    v_sub_u32 v4, v4, v75
    v_and_b32 v4, 7, v4
    v_lshl_or_b32 v4, v4, 18, v11
    v_and_b32 v3, 0x7fff, v15
    v_or_b32 v54, v3, v4
    ds_write_b32 v28, v42 offset:8
    ds_write_b32 v29, v46 offset:8
    ds_write_b32 v30, v50 offset:8
    ds_write_b32 v31, v54 offset:8
    s_waitcnt vmcnt(2)
    v_lshlrev_b32 v56, 16, v16
    v_and_b32 v57, s23, v16
    v_lshlrev_b32 v58, 16, v17
    v_and_b32 v59, s23, v17
    s_waitcnt vmcnt(0)
    v_cmp_gt_u32 vcc, 64, v0
    s_cbranch_vccz P_nodesc
    s_lshl_b32 s3, s2, 10
    s_add_u32 s3, s3, 16777216
    v_lshl_add_u32 v1, v0, 4, s3
    global_store_dwordx4 v1, v[84:87], s[18:19] sc1
P_nodesc:
    v_lshlrev_b32 v60, 16, v20
    v_and_b32 v61, s23, v20
    v_lshlrev_b32 v62, 16, v21
    v_and_b32 v63, s23, v21
    v_lshlrev_b32 v64, 16, v22
    v_and_b32 v65, s23, v22
    v_lshlrev_b32 v66, 16, v23
    v_and_b32 v67, s23, v23
    v_lshlrev_b32 v68, 16, v24
    v_and_b32 v69, s23, v24
    v_lshlrev_b32 v70, 16, v25
    v_and_b32 v71, s23, v25
    v_mul_f32 v60, v56, v60
    v_mul_f32 v61, v56, v61
    v_mul_f32 v62, v56, v62
    v_cvt_pk_bf16_f32 v40, v56, v60
    v_cvt_pk_bf16_f32 v41, v61, v62
    ds_write2_b32 v28, v40, v41 offset0:0 offset1:1
    v_mul_f32 v63, v57, v63
    v_mul_f32 v64, v57, v64
    v_mul_f32 v65, v57, v65
    v_cvt_pk_bf16_f32 v44, v57, v63
    v_cvt_pk_bf16_f32 v45, v64, v65
    ds_write2_b32 v29, v44, v45 offset0:0 offset1:1
    v_mul_f32 v66, v58, v66
    v_mul_f32 v67, v58, v67
    v_mul_f32 v68, v58, v68
    v_cvt_pk_bf16_f32 v48, v58, v66
    v_cvt_pk_bf16_f32 v49, v67, v68
    ds_write2_b32 v30, v48, v49 offset0:0 offset1:1
    v_mul_f32 v69, v59, v69
    v_mul_f32 v70, v59, v70
    v_mul_f32 v71, v59, v71
    v_cvt_pk_bf16_f32 v52, v59, v69
    v_cvt_pk_bf16_f32 v53, v70, v71
    ds_write2_b32 v31, v52, v53 offset0:0 offset1:1
    s_mul_i32 s3, s2, 38400
    s_mov_b64 exec, -1
    v_lshlrev_b32 v1, 4, v0
    v_add_u32 v2, s3, v1
    s_waitcnt lgkmcnt(0)
    s_barrier
    ds_read_b128 v[8:11], v1 offset:1024
    ds_read_b128 v[12:15], v1 offset:14336
    ds_read_b128 v[16:19], v1 offset:27648
    v_add_u32 v3, 13312, v2
    v_add_u32 v4, 26624, v2
    v_cmp_gt_u32 vcc, 736, v0
    s_waitcnt lgkmcnt(2)
    global_store_dwordx4 v2, v[8:11], s[18:19] sc1
    s_waitcnt lgkmcnt(1)
    global_store_dwordx4 v3, v[12:15], s[18:19] sc1
    s_and_saveexec_b64 s[20:21], vcc
    s_cbranch_execz P_fin
    s_waitcnt lgkmcnt(0)
    global_store_dwordx4 v4, v[16:19], s[18:19] sc1
P_fin:
    s_branch P_done
P_prep:
    s_waitcnt lgkmcnt(0)
    s_lshl_b32 s3, s2, 10
    s_add_u32 s3, s3, 16777216
    v_lshlrev_b32 v1, 2, v0
    v_add_u32 v1, s3, v1
    v_mov_b32 v2, 0
    v_cmp_gt_u32 vcc, 256, v0
    s_and_saveexec_b64 s[20:21], vcc
    s_cbranch_execz P_prep1
    global_store_dword v1, v2, s[18:19] sc1
P_prep1:
    s_mov_b64 exec, s[20:21]
    s_sub_u32 s3, s2, 250
    s_cmp_eq_u32 s3, 5
    s_cbranch_scc1 P_done
    v_cmp_gt_u32 vcc, 512, v0
    s_and_saveexec_b64 s[20:21], vcc
    s_cbranch_execz P_done
    s_cmp_lt_u32 s3, 2
    s_cselect_b32 s24, s14, s16
    s_cselect_b32 s25, s15, s17
    s_sub_u32 s22, s3, 2
    s_cselect_b32 s22, s3, s22
    s_lshl_b32 s22, s22, 13
    v_lshrrev_b32 v1, 8, v0
    v_bfe_u32 v2, v0, 4, 2
    v_lshl_add_u32 v1, v2, 2, v1
    s_lshl_b32 s23, s3, 7
    v_lshl_add_u32 v4, v1, 3, s23
    global_load_dwordx2 v[16:17], v4, s[12:13]
    global_load_dwordx2 v[18:19], v4, s[12:13] offset:16
    v_lshlrev_b32 v1, 9, v1
    v_bfe_u32 v2, v0, 7, 1
    v_bfe_u32 v3, v0, 2, 2
    v_lshl_add_u32 v2, v2, 2, v3
    v_bfe_u32 v3, v0, 6, 1
    v_lshl_add_u32 v2, v2, 1, v3
    v_and_b32 v3, 3, v0
    v_lshl_add_u32 v2, v2, 2, v3
    v_lshl_add_u32 v1, v2, 1, v1
    v_add_u32 v1, s22, v1
    global_load_ushort v8, v1, s[24:25] offset:0
    global_load_ushort v9, v1, s[24:25] offset:128
    global_load_ushort v10, v1, s[24:25] offset:256
    global_load_ushort v11, v1, s[24:25] offset:384
    global_load_ushort v12, v1, s[24:25] offset:1024
    global_load_ushort v13, v1, s[24:25] offset:1152
    global_load_ushort v14, v1, s[24:25] offset:1280
    global_load_ushort v15, v1, s[24:25] offset:1408
    s_lshl_b32 s3, s3, 13
    s_add_u32 s3, s3, 17825792
    v_lshl_add_u32 v1, v0, 4, s3
    s_mov_b32 s23, 0xffff0000
    s_waitcnt vmcnt(0)
    v_lshlrev_b32 v8, 16, v8
    v_lshlrev_b32 v2, 16, v16
    v_mul_f32 v8, v8, v2
    v_lshlrev_b32 v9, 16, v9
    v_and_b32 v2, s23, v16
    v_mul_f32 v9, v9, v2
    v_lshlrev_b32 v10, 16, v10
    v_lshlrev_b32 v2, 16, v17
    v_mul_f32 v10, v10, v2
    v_lshlrev_b32 v11, 16, v11
    v_and_b32 v2, s23, v17
    v_mul_f32 v11, v11, v2
    v_lshlrev_b32 v12, 16, v12
    v_lshlrev_b32 v2, 16, v18
    v_mul_f32 v12, v12, v2
    v_lshlrev_b32 v13, 16, v13
    v_and_b32 v2, s23, v18
    v_mul_f32 v13, v13, v2
    v_lshlrev_b32 v14, 16, v14
    v_lshlrev_b32 v2, 16, v19
    v_mul_f32 v14, v14, v2
    v_lshlrev_b32 v15, 16, v15
    v_and_b32 v2, s23, v19
    v_mul_f32 v15, v15, v2
    v_cvt_pk_bf16_f32 v4, v8, v9
    v_cvt_pk_bf16_f32 v5, v10, v11
    v_cvt_pk_bf16_f32 v6, v12, v13
    v_cvt_pk_bf16_f32 v7, v14, v15
    global_store_dwordx4 v1, v[4:7], s[18:19] sc1
P_done:
    s_endpgm
    .p2align 8
    .globl main_kernel
    .type main_kernel,@function
main_kernel:
    s_cmp_ge_u32 s2, 256
    s_cbranch_scc1 M_done
    s_load_dwordx2 s[16:17], s[0:1], 88
    s_load_dwordx2 s[24:25], s[0:1], 0
    s_load_dwordx2 s[26:27], s[0:1], 72
    v_lshrrev_b32 v1, 6, v0
    v_and_b32 v3, 63, v0
    v_readfirstlane_b32 s18, v1
    s_mov_b32 s19, 0
    s_movk_i32 s20, 48
    s_mul_i32 s22, s18, 10240
    s_add_u32 s22, s22, 54784
    s_and_b32 s3, s2, 7
    s_lshl_b32 s3, s3, 5
    s_lshr_b32 s2, s2, 3
    s_or_b32 s2, s2, s3
    s_waitcnt lgkmcnt(0)
    s_mov_b32 s4, s24
    s_and_b32 s5, s25, 0xffff
    s_or_b32 s5, s5, 0x2000000
    s_mov_b32 s6, 25000
    s_mov_b32 s7, 0x20000
    s_mov_b32 s12, s26
    s_and_b32 s13, s27, 0xffff
    s_mov_b32 s14, 12800000
    s_mov_b32 s15, 0x20000
    s_mov_b32 s8, s16
    s_and_b32 s9, s17, 0xffff
    s_mov_b32 s10, 17866752
    s_mov_b32 s11, 0x20000
    s_add_u32 s92, s16, 33554432
    s_addc_u32 s93, s17, 0
    s_and_b32 s93, s93, 0xffff
    s_mov_b32 s94, 25690112
    s_mov_b32 s95, 0x20000
M_round:
    v_lshrrev_b32 v1, 3, v3
    s_lshl_b32 s24, s18, 3
    v_add_u32 v1, s24, v1
    s_lshl_b32 s24, s2, 2
    s_add_u32 s24, s24, 16777216
    v_lshl_add_u32 v4, v1, 12, s24
    global_load_dword v128, v4, s[16:17]
    global_load_dword v129, v4, s[16:17] offset:1024
    global_load_dword v130, v4, s[16:17] offset:2048
    global_load_dword v131, v4, s[16:17] offset:3072
    s_lshl_b32 s24, s18, 9
    v_lshl_add_u32 v0, v3, 3, s24
    v_mov_b32 v4, 0
    v_mov_b32 v5, 0
    v_mov_b32 v6, 0x7fff
    v_mov_b32 v7, 0
    ds_write_b64 v0, v[4:5] offset:512
    ds_write_b64 v4, v[4:5] offset:0
    v_lshlrev_b32 v2, 3, v3
    ds_write_b64 v2, v[4:5] offset:12800
    v_lshl_add_u32 v2, v3, 4, s22
    ds_write_b128 v2, v[4:7] offset:0
    ds_write_b128 v2, v[4:7] offset:1024
    ds_write_b128 v2, v[4:7] offset:2048
    ds_write_b128 v2, v[4:7] offset:3072
    ds_write_b128 v2, v[4:7] offset:4096
    ds_write_b128 v2, v[4:7] offset:5120
    ds_write_b128 v2, v[4:7] offset:6144
    ds_write_b128 v2, v[4:7] offset:7168
    ds_write_b128 v2, v[4:7] offset:8192
    ds_write_b128 v2, v[4:7] offset:9216
    s_mov_b32 s24, 153600
    v_mul_lo_u32 v1, v1, s24
    v_and_b32 v0, 7, v3
    v_add_u32 v0, s19, v0
    s_movk_i32 s24, 12
    v_mad_u32_u24 v1, v0, s24, v1
    s_add_u32 s25, s19, s20
    v_mov_b32 v24, 0
    v_mov_b32 v25, 0x7ffff000
    s_waitcnt vmcnt(0)
    v_lshrrev_b32 v26, 16, v128
    v_max_u32 v24, v24, v26
    v_min_u32 v26, s25, v26
    v_sub_u32 v26, v26, v0
    v_and_b32 v128, 0xffff, v128
    v_mad_u32_u24 v128, v128, s24, v1
    v_cmp_lt_i32 s[44:45], 0, v26
    v_cmp_lt_i32 s[52:53], 8, v26
    v_cmp_lt_i32 s[60:61], 16, v26
    v_cmp_lt_i32 s[68:69], 24, v26
    v_cmp_lt_i32 s[76:77], 32, v26
    v_cmp_lt_i32 s[84:85], 40, v26
    v_add_u32 v1, 38400, v1
    v_lshrrev_b32 v26, 16, v129
    v_max_u32 v24, v24, v26
    v_min_u32 v26, s25, v26
    v_sub_u32 v26, v26, v0
    v_and_b32 v129, 0xffff, v129
    v_mad_u32_u24 v129, v129, s24, v1
    v_cmp_lt_i32 s[46:47], 0, v26
    v_cmp_lt_i32 s[54:55], 8, v26
    v_cmp_lt_i32 s[62:63], 16, v26
    v_cmp_lt_i32 s[70:71], 24, v26
    v_cmp_lt_i32 s[78:79], 32, v26
    v_cmp_lt_i32 s[86:87], 40, v26
    v_add_u32 v1, 38400, v1
    v_lshrrev_b32 v26, 16, v130
    v_max_u32 v24, v24, v26
    v_min_u32 v26, s25, v26
    v_sub_u32 v26, v26, v0
    v_and_b32 v130, 0xffff, v130
    v_mad_u32_u24 v130, v130, s24, v1
    v_cmp_lt_i32 s[48:49], 0, v26
    v_cmp_lt_i32 s[56:57], 8, v26
    v_cmp_lt_i32 s[64:65], 16, v26
    v_cmp_lt_i32 s[72:73], 24, v26
    v_cmp_lt_i32 s[80:81], 32, v26
    v_cmp_lt_i32 s[88:89], 40, v26
    v_add_u32 v1, 38400, v1
    v_lshrrev_b32 v26, 16, v131
    v_max_u32 v24, v24, v26
    v_min_u32 v26, s25, v26
    v_sub_u32 v26, v26, v0
    v_and_b32 v131, 0xffff, v131
    v_mad_u32_u24 v131, v131, s24, v1
    v_cmp_lt_i32 s[50:51], 0, v26
    v_cmp_lt_i32 s[58:59], 8, v26
    v_cmp_lt_i32 s[66:67], 16, v26
    v_cmp_lt_i32 s[74:75], 24, v26
    v_cmp_lt_i32 s[82:83], 32, v26
    v_cmp_lt_i32 s[90:91], 40, v26
    s_mov_b32 s41, 2
    s_or_b64 s[26:27], s[60:61], s[62:63]
    s_or_b64 s[26:27], s[26:27], s[64:65]
    s_or_b64 s[26:27], s[26:27], s[66:67]
    s_cselect_b32 s41, 3, s41
    s_or_b64 s[26:27], s[68:69], s[70:71]
    s_or_b64 s[26:27], s[26:27], s[72:73]
    s_or_b64 s[26:27], s[26:27], s[74:75]
    s_cselect_b32 s41, 4, s41
    s_or_b64 s[26:27], s[76:77], s[78:79]
    s_or_b64 s[26:27], s[26:27], s[80:81]
    s_or_b64 s[26:27], s[26:27], s[82:83]
    s_cselect_b32 s41, 5, s41
    s_or_b64 s[26:27], s[84:85], s[86:87]
    s_or_b64 s[26:27], s[26:27], s[88:89]
    s_or_b64 s[26:27], s[26:27], s[90:91]
    s_cselect_b32 s41, 6, s41
    s_cmp_eq_u32 s41, 2
    s_cbranch_scc1 M_ld_1
    s_cmp_eq_u32 s41, 3
    s_cbranch_scc1 M_ld_2
    s_cmp_eq_u32 s41, 4
    s_cbranch_scc1 M_ld_3
    s_cmp_eq_u32 s41, 5
    s_cbranch_scc1 M_ld_4
M_ld_5:
    v_cndmask_b32 v243, v25, v128, s[84:85]
    buffer_load_dwordx3 v[240:242], v243, s[8:11], 0 offen offset:480
    v_cndmask_b32 v247, v25, v129, s[86:87]
    buffer_load_dwordx3 v[244:246], v247, s[8:11], 0 offen offset:480
    v_cndmask_b32 v251, v25, v130, s[88:89]
    buffer_load_dwordx3 v[248:250], v251, s[8:11], 0 offen offset:480
    v_cndmask_b32 v255, v25, v131, s[90:91]
    buffer_load_dwordx3 v[252:254], v255, s[8:11], 0 offen offset:480
M_ld_4:
    v_cndmask_b32 v227, v25, v128, s[76:77]
    buffer_load_dwordx3 v[224:226], v227, s[8:11], 0 offen offset:384
    v_cndmask_b32 v231, v25, v129, s[78:79]
    buffer_load_dwordx3 v[228:230], v231, s[8:11], 0 offen offset:384
    v_cndmask_b32 v235, v25, v130, s[80:81]
    buffer_load_dwordx3 v[232:234], v235, s[8:11], 0 offen offset:384
    v_cndmask_b32 v239, v25, v131, s[82:83]
    buffer_load_dwordx3 v[236:238], v239, s[8:11], 0 offen offset:384
M_ld_3:
    v_cndmask_b32 v211, v25, v128, s[68:69]
    buffer_load_dwordx3 v[208:210], v211, s[8:11], 0 offen offset:288
    v_cndmask_b32 v215, v25, v129, s[70:71]
    buffer_load_dwordx3 v[212:214], v215, s[8:11], 0 offen offset:288
    v_cndmask_b32 v219, v25, v130, s[72:73]
    buffer_load_dwordx3 v[216:218], v219, s[8:11], 0 offen offset:288
    v_cndmask_b32 v223, v25, v131, s[74:75]
    buffer_load_dwordx3 v[220:222], v223, s[8:11], 0 offen offset:288
M_ld_2:
    v_cndmask_b32 v195, v25, v128, s[60:61]
    buffer_load_dwordx3 v[192:194], v195, s[8:11], 0 offen offset:192
    v_cndmask_b32 v199, v25, v129, s[62:63]
    buffer_load_dwordx3 v[196:198], v199, s[8:11], 0 offen offset:192
    v_cndmask_b32 v203, v25, v130, s[64:65]
    buffer_load_dwordx3 v[200:202], v203, s[8:11], 0 offen offset:192
    v_cndmask_b32 v207, v25, v131, s[66:67]
    buffer_load_dwordx3 v[204:206], v207, s[8:11], 0 offen offset:192
M_ld_1:
    v_cndmask_b32 v179, v25, v128, s[52:53]
    buffer_load_dwordx3 v[176:178], v179, s[8:11], 0 offen offset:96
    v_cndmask_b32 v183, v25, v129, s[54:55]
    buffer_load_dwordx3 v[180:182], v183, s[8:11], 0 offen offset:96
    v_cndmask_b32 v187, v25, v130, s[56:57]
    buffer_load_dwordx3 v[184:186], v187, s[8:11], 0 offen offset:96
    v_cndmask_b32 v191, v25, v131, s[58:59]
    buffer_load_dwordx3 v[188:190], v191, s[8:11], 0 offen offset:96
M_ld_0:
    v_cndmask_b32 v163, v25, v128, s[44:45]
    buffer_load_dwordx3 v[160:162], v163, s[8:11], 0 offen offset:0
    v_cndmask_b32 v167, v25, v129, s[46:47]
    buffer_load_dwordx3 v[164:166], v167, s[8:11], 0 offen offset:0
    v_cndmask_b32 v171, v25, v130, s[48:49]
    buffer_load_dwordx3 v[168:170], v171, s[8:11], 0 offen offset:0
    v_cndmask_b32 v175, v25, v131, s[50:51]
    buffer_load_dwordx3 v[172:174], v175, s[8:11], 0 offen offset:0
    s_waitcnt lgkmcnt(0)
    s_barrier
    v_cmp_lt_u32 vcc, s25, v24
    s_and_saveexec_b64 s[26:27], vcc
    v_mov_b32 v1, 1
    ds_write_b32 v4, v1 offset:4
    s_mov_b64 exec, -1
    v_mov_b32 v6, 0
    v_and_b32 v12, 31, v3
    v_lshrrev_b32 v24, 5, v3
    v_lshl_add_u32 v2, v24, 4, s22
    v_mfma_f32_32x32x16_bf16 v[48:63], v[4:7], v[4:7], 0
    v_mfma_f32_32x32x16_bf16 v[64:79], v[4:7], v[4:7], 0
    v_mfma_f32_32x32x16_bf16 v[80:95], v[4:7], v[4:7], 0
    v_mfma_f32_32x32x16_bf16 v[96:111], v[4:7], v[4:7], 0
    v_mfma_f32_32x32x16_bf16 v[112:127], v[4:7], v[4:7], 0
    v_lshrrev_b32 v24, 3, v12
    v_mul_u32_u24 v24, 0x202, v24
    v_add_u32 v24, 0x0c0c0100, v24
    v_mov_b32 v27, 0x0c0c0c0c
    v_and_b32 v25, 4, v12
    v_cmp_eq_u32 vcc, 0, v25
    v_and_b32 v10, 3, v12
    v_mul_u32_u24 v10, 0x5555, v10
    v_cndmask_b32 v8, v27, v24, vcc
    v_cndmask_b32 v9, v24, v27, vcc
    v_lshlrev_b32 v15, 4, v12
    s_and_b32 s24, s2, 31
    s_lshl_b32 s24, s24, 3
    s_add_u32 s24, s24, s18
    s_mul_i32 s24, s24, 13
    s_lshr_b32 s26, s2, 5
    s_mul_i32 s26, s26, 3125
    s_add_u32 s24, s24, s26
    v_lshrrev_b32 v156, 2, v3
    v_add_u32 v156, s24, v156
    v_and_b32 v157, 3, v3
    v_lshlrev_b32 v157, 7, v157
    v_cmp_gt_u32 vcc, 52, v3
    v_mov_b32 v24, 0x7fff
    s_mov_b32 m0, 256
    v_cndmask_b32 v156, v24, v156, vcc
    v_and_b32 v12, 7, v3
    s_lshl_b32 s24, s18, 6
    v_lshl_add_u32 v13, v12, 3, s24
    v_lshrrev_b32 v14, 3, v3
    v_lshlrev_b32 v14, 2, v14
    v_lshlrev_b32 v16, 5, v3
    v_mov_b32 v1, 2
    v_lshlrev_b32 v20, 4, v12
    v_add_u32 v20, s18, v20
    v_add_u32 v21, 8, v20
    ds_write_b64 v13, v[20:21] offset:13312
    v_lshlrev_b32 v12, 2, v12
    s_waitcnt vmcnt(8)
    s_cmp_eq_u32 s41, 2
    s_cbranch_scc1 M_at_1
    s_cmp_eq_u32 s41, 3
    s_cbranch_scc1 M_at_2
    s_cmp_eq_u32 s41, 4
    s_cbranch_scc1 M_at_3
    s_cmp_eq_u32 s41, 5
    s_cbranch_scc1 M_at_4
M_at_5:
    s_mov_b64 exec, s[84:85]
    v_lshrrev_b32 v243, 16, v242
    ds_add_rtn_u32 v152, v243, v1 offset:512
    s_mov_b64 exec, s[86:87]
    v_lshrrev_b32 v247, 16, v246
    ds_add_rtn_u32 v153, v247, v1 offset:512
    s_mov_b64 exec, s[88:89]
    v_lshrrev_b32 v251, 16, v250
    ds_add_rtn_u32 v154, v251, v1 offset:512
    s_mov_b64 exec, s[90:91]
    v_lshrrev_b32 v255, 16, v254
    ds_add_rtn_u32 v155, v255, v1 offset:512
M_at_4:
    s_mov_b64 exec, s[76:77]
    v_lshrrev_b32 v227, 16, v226
    ds_add_rtn_u32 v148, v227, v1 offset:512
    s_mov_b64 exec, s[78:79]
    v_lshrrev_b32 v231, 16, v230
    ds_add_rtn_u32 v149, v231, v1 offset:512
    s_mov_b64 exec, s[80:81]
    v_lshrrev_b32 v235, 16, v234
    ds_add_rtn_u32 v150, v235, v1 offset:512
    s_mov_b64 exec, s[82:83]
    v_lshrrev_b32 v239, 16, v238
    ds_add_rtn_u32 v151, v239, v1 offset:512
M_at_3:
    s_mov_b64 exec, s[68:69]
    v_lshrrev_b32 v211, 16, v210
    ds_add_rtn_u32 v144, v211, v1 offset:512
    s_mov_b64 exec, s[70:71]
    v_lshrrev_b32 v215, 16, v214
    ds_add_rtn_u32 v145, v215, v1 offset:512
    s_mov_b64 exec, s[72:73]
    v_lshrrev_b32 v219, 16, v218
    ds_add_rtn_u32 v146, v219, v1 offset:512
    s_mov_b64 exec, s[74:75]
    v_lshrrev_b32 v223, 16, v222
    ds_add_rtn_u32 v147, v223, v1 offset:512
M_at_2:
    s_mov_b64 exec, s[60:61]
    v_lshrrev_b32 v195, 16, v194
    ds_add_rtn_u32 v140, v195, v1 offset:512
    s_mov_b64 exec, s[62:63]
    v_lshrrev_b32 v199, 16, v198
    ds_add_rtn_u32 v141, v199, v1 offset:512
    s_mov_b64 exec, s[64:65]
    v_lshrrev_b32 v203, 16, v202
    ds_add_rtn_u32 v142, v203, v1 offset:512
    s_mov_b64 exec, s[66:67]
    v_lshrrev_b32 v207, 16, v206
    ds_add_rtn_u32 v143, v207, v1 offset:512
M_at_1:
    s_waitcnt vmcnt(7)
    s_mov_b64 exec, s[52:53]
    v_lshrrev_b32 v179, 16, v178
    ds_add_rtn_u32 v136, v179, v1 offset:512
    s_waitcnt vmcnt(6)
    s_mov_b64 exec, s[54:55]
    v_lshrrev_b32 v183, 16, v182
    ds_add_rtn_u32 v137, v183, v1 offset:512
    s_waitcnt vmcnt(5)
    s_mov_b64 exec, s[56:57]
    v_lshrrev_b32 v187, 16, v186
    ds_add_rtn_u32 v138, v187, v1 offset:512
    s_waitcnt vmcnt(4)
    s_mov_b64 exec, s[58:59]
    v_lshrrev_b32 v191, 16, v190
    ds_add_rtn_u32 v139, v191, v1 offset:512
M_at_0:
    s_waitcnt vmcnt(3)
    s_mov_b64 exec, s[44:45]
    v_lshrrev_b32 v163, 16, v162
    ds_add_rtn_u32 v132, v163, v1 offset:512
    s_waitcnt vmcnt(2)
    s_mov_b64 exec, s[46:47]
    v_lshrrev_b32 v167, 16, v166
    ds_add_rtn_u32 v133, v167, v1 offset:512
    s_waitcnt vmcnt(1)
    s_mov_b64 exec, s[48:49]
    v_lshrrev_b32 v171, 16, v170
    ds_add_rtn_u32 v134, v171, v1 offset:512
    s_waitcnt vmcnt(0)
    s_mov_b64 exec, s[50:51]
    v_lshrrev_b32 v175, 16, v174
    ds_add_rtn_u32 v135, v175, v1 offset:512
    s_mov_b64 exec, -1
    s_mul_i32 s24, s18, 5120
    s_add_u32 s26, s24, 13824
    s_mov_b32 m0, s26
    s_add_u32 s24, s24, 17825792
    v_lshl_add_u32 v158, v3, 4, s24
    buffer_load_dwordx4 v158, s[8:11], 0 offen offset:0 lds
    buffer_load_dwordx4 v158, s[8:11], 0 offen offset:1024 lds
    buffer_load_dwordx4 v158, s[8:11], 0 offen offset:2048 lds
    buffer_load_dwordx4 v158, s[8:11], 0 offen offset:3072 lds
    s_add_u32 s26, s26, 4096
    s_mov_b32 m0, s26
    v_add_u32 v158, 4096, v158
    buffer_load_dwordx4 v158, s[8:11], 0 offen lds
    s_mov_b32 m0, 256
    s_nop 0
    s_waitcnt lgkmcnt(0)
    s_barrier
    buffer_load_dword v[156:157], s[4:7], 0 idxen offen lds
    v_lshlrev_b32 v20, 5, v20
    v_lshlrev_b32 v21, 5, v21
    ds_read_b128 v[24:27], v20 offset:512
    ds_read_b128 v[28:31], v20 offset:528
    ds_read_b128 v[32:35], v21 offset:512
    ds_read_b128 v[36:39], v21 offset:528
    v_add_u32 v20, v14, v20
    v_add_u32 v21, v14, v21
    ds_read_b32 v40, v20 offset:512
    ds_read_b32 v41, v21 offset:512
    s_cmp_eq_u32 s41, 2
    s_cbranch_scc1 M_ta_1
    s_cmp_eq_u32 s41, 3
    s_cbranch_scc1 M_ta_2
    s_cmp_eq_u32 s41, 4
    s_cbranch_scc1 M_ta_3
    s_cmp_eq_u32 s41, 5
    s_cbranch_scc1 M_ta_4
M_ta_5:
    s_mov_b64 exec, s[84:85]
    v_min_u32 v0, 2, v152
    v_add_lshl_u32 v243, v243, v0, 1
    s_mov_b64 exec, s[86:87]
    v_min_u32 v0, 2, v153
    v_add_lshl_u32 v247, v247, v0, 1
    s_mov_b64 exec, s[88:89]
    v_min_u32 v0, 2, v154
    v_add_lshl_u32 v251, v251, v0, 1
    s_mov_b64 exec, s[90:91]
    v_min_u32 v0, 2, v155
    v_add_lshl_u32 v255, v255, v0, 1
M_ta_4:
    s_mov_b64 exec, s[76:77]
    v_min_u32 v0, 2, v148
    v_add_lshl_u32 v227, v227, v0, 1
    s_mov_b64 exec, s[78:79]
    v_min_u32 v0, 2, v149
    v_add_lshl_u32 v231, v231, v0, 1
    s_mov_b64 exec, s[80:81]
    v_min_u32 v0, 2, v150
    v_add_lshl_u32 v235, v235, v0, 1
    s_mov_b64 exec, s[82:83]
    v_min_u32 v0, 2, v151
    v_add_lshl_u32 v239, v239, v0, 1
M_ta_3:
    s_mov_b64 exec, s[68:69]
    v_min_u32 v0, 2, v144
    v_add_lshl_u32 v211, v211, v0, 1
    s_mov_b64 exec, s[70:71]
    v_min_u32 v0, 2, v145
    v_add_lshl_u32 v215, v215, v0, 1
    s_mov_b64 exec, s[72:73]
    v_min_u32 v0, 2, v146
    v_add_lshl_u32 v219, v219, v0, 1
    s_mov_b64 exec, s[74:75]
    v_min_u32 v0, 2, v147
    v_add_lshl_u32 v223, v223, v0, 1
M_ta_2:
    s_mov_b64 exec, s[60:61]
    v_min_u32 v0, 2, v140
    v_add_lshl_u32 v195, v195, v0, 1
    s_mov_b64 exec, s[62:63]
    v_min_u32 v0, 2, v141
    v_add_lshl_u32 v199, v199, v0, 1
    s_mov_b64 exec, s[64:65]
    v_min_u32 v0, 2, v142
    v_add_lshl_u32 v203, v203, v0, 1
    s_mov_b64 exec, s[66:67]
    v_min_u32 v0, 2, v143
    v_add_lshl_u32 v207, v207, v0, 1
M_ta_1:
    s_mov_b64 exec, s[52:53]
    v_min_u32 v0, 2, v136
    v_add_lshl_u32 v179, v179, v0, 1
    s_mov_b64 exec, s[54:55]
    v_min_u32 v0, 2, v137
    v_add_lshl_u32 v183, v183, v0, 1
    s_mov_b64 exec, s[56:57]
    v_min_u32 v0, 2, v138
    v_add_lshl_u32 v187, v187, v0, 1
    s_mov_b64 exec, s[58:59]
    v_min_u32 v0, 2, v139
    v_add_lshl_u32 v191, v191, v0, 1
M_ta_0:
    s_mov_b64 exec, s[44:45]
    v_min_u32 v0, 2, v132
    v_add_lshl_u32 v163, v163, v0, 1
    s_mov_b64 exec, s[46:47]
    v_min_u32 v0, 2, v133
    v_add_lshl_u32 v167, v167, v0, 1
    s_mov_b64 exec, s[48:49]
    v_min_u32 v0, 2, v134
    v_add_lshl_u32 v171, v171, v0, 1
    s_mov_b64 exec, s[50:51]
    v_min_u32 v0, 2, v135
    v_add_lshl_u32 v175, v175, v0, 1
    s_mov_b64 exec, -1
    v_mov_b32 v42, 0
    v_mov_b32 v43, 0
    v_mov_b32 v44, v12
    v_mov_b32 v45, v12
    v_lshlrev_b32 v20, 1, v20
    v_lshlrev_b32 v21, 1, v21
    s_waitcnt lgkmcnt(0)
    s_mov_b32 exec_lo, 0xffffff00
    v_cmp_ne_u32 vcc, 0, v24
    v_cmp_ne_u32 s[26:27], 0, v32
    v_add_u32 v42, v42, v24
    v_add_u32 v43, v43, v32
    v_cndmask_b32 v44, v44, v12, vcc
    v_cndmask_b32 v45, v45, v12, s[26:27]
    v_add_u32 v12, 32, v12
    s_mov_b32 exec_lo, 0xffff0000
    v_cmp_ne_u32 vcc, 0, v25
    v_cmp_ne_u32 s[26:27], 0, v33
    v_add_u32 v42, v42, v25
    v_add_u32 v43, v43, v33
    v_cndmask_b32 v44, v44, v12, vcc
    v_cndmask_b32 v45, v45, v12, s[26:27]
    v_add_u32 v12, 32, v12
    s_mov_b32 exec_lo, 0xff000000
    v_cmp_ne_u32 vcc, 0, v26
    v_cmp_ne_u32 s[26:27], 0, v34
    v_add_u32 v42, v42, v26
    v_add_u32 v43, v43, v34
    v_cndmask_b32 v44, v44, v12, vcc
    v_cndmask_b32 v45, v45, v12, s[26:27]
    v_add_u32 v12, 32, v12
    s_mov_b32 exec_lo, 0x0
    v_cmp_ne_u32 vcc, 0, v27
    v_cmp_ne_u32 s[26:27], 0, v35
    v_add_u32 v42, v42, v27
    v_add_u32 v43, v43, v35
    v_cndmask_b32 v44, v44, v12, vcc
    v_cndmask_b32 v45, v45, v12, s[26:27]
    v_add_u32 v12, 32, v12
    s_mov_b32 exec_hi, 0xffffff00
    v_cmp_ne_u32 vcc, 0, v28
    v_cmp_ne_u32 s[26:27], 0, v36
    v_add_u32 v42, v42, v28
    v_add_u32 v43, v43, v36
    v_cndmask_b32 v44, v44, v12, vcc
    v_cndmask_b32 v45, v45, v12, s[26:27]
    v_add_u32 v12, 32, v12
    s_mov_b32 exec_hi, 0xffff0000
    v_cmp_ne_u32 vcc, 0, v29
    v_cmp_ne_u32 s[26:27], 0, v37
    v_add_u32 v42, v42, v29
    v_add_u32 v43, v43, v37
    v_cndmask_b32 v44, v44, v12, vcc
    v_cndmask_b32 v45, v45, v12, s[26:27]
    v_add_u32 v12, 32, v12
    s_mov_b32 exec_hi, 0xff000000
    v_cmp_ne_u32 vcc, 0, v30
    v_cmp_ne_u32 s[26:27], 0, v38
    v_add_u32 v42, v42, v30
    v_add_u32 v43, v43, v38
    v_cndmask_b32 v44, v44, v12, vcc
    v_cndmask_b32 v45, v45, v12, s[26:27]
    v_add_u32 v12, 32, v12
    s_mov_b64 exec, -1
    v_add_u32 v46, 2, v42
    v_add_u32 v47, 2, v43
    v_add_u32 v0, v46, v40
    v_add_u32 v1, v47, v41
    v_lshrrev_b32 v46, 2, v46
    v_lshrrev_b32 v47, 2, v47
    v_lshrrev_b32 v0, 2, v0
    v_lshrrev_b32 v1, 2, v1
    v_sub_u32 v0, v0, v46
    v_sub_u32 v1, v1, v47
    v_add_u32 v24, v0, v1
    v_mov_b32 v25, v24
    s_nop 1
    v_add_u32_dpp v25, v25, v25 row_shr:1 row_mask:0xf bank_mask:0xf bound_ctrl:0
    s_nop 1
    v_add_u32_dpp v25, v25, v25 row_shr:2 row_mask:0xf bank_mask:0xf bound_ctrl:0
    s_nop 1
    v_add_u32_dpp v25, v25, v25 row_shr:4 row_mask:0xf bank_mask:0xf bound_ctrl:0
    s_nop 1
    v_add_u32_dpp v25, v25, v25 row_shr:8 row_mask:0xf bank_mask:0xf bound_ctrl:0
    s_nop 1
    v_add_u32_dpp v25, v25, v25 row_bcast:15 row_mask:0xa bank_mask:0xf
    s_nop 1
    v_add_u32_dpp v25, v25, v25 row_bcast:31 row_mask:0xc bank_mask:0xf
    s_nop 1
    v_readlane_b32 s24, v25, 63
    v_sub_u32 v24, v25, v24
    v_lshl_add_u32 v27, v24, 5, s22
    v_lshl_add_u32 v29, v0, 5, v27
    v_and_b32 v42, 2, v42
    v_and_b32 v43, 2, v43
    v_lshlrev_b32 v46, 3, v42
    v_lshlrev_b32 v47, 3, v43
    v_sub_u32 v27, v27, v46
    v_sub_u32 v29, v29, v47
    v_lshl_add_u32 v46, v40, 3, v27
    v_lshl_add_u32 v47, v41, 3, v29
    ds_bpermute_b32 v26, v44, v46
    ds_bpermute_b32 v28, v45, v47
    v_cmp_eq_u32 vcc, 0, v42
    v_cmp_eq_u32 s[26:27], 0, v43
    s_cmp_le_u32 s24, 309
    s_cbranch_scc1 M_noovf
    v_mov_b32 v30, 1
    ds_write_b32 v4, v30 offset:0
M_noovf:
    s_waitcnt lgkmcnt(0)
    v_cndmask_b32 v26, v26, v27, vcc
    v_cndmask_b32 v28, v28, v29, s[26:27]
    ds_write_b64 v20, v[26:27] offset:4608
    ds_write_b64 v21, v[28:29] offset:4608
    s_waitcnt lgkmcnt(0)
    s_barrier
    ds_read_b64 v[20:21], v4 offset:0
    s_cmp_eq_u32 s41, 2
    s_cbranch_scc1 M_lk_1
    s_cmp_eq_u32 s41, 3
    s_cbranch_scc1 M_lk_2
    s_cmp_eq_u32 s41, 4
    s_cbranch_scc1 M_lk_3
    s_cmp_eq_u32 s41, 5
    s_cbranch_scc1 M_lk_4
M_lk_5:
    s_mov_b64 exec, s[84:85]
    ds_read_b32 v243, v243 offset:4608
    s_mov_b64 exec, s[86:87]
    ds_read_b32 v247, v247 offset:4608
    s_mov_b64 exec, s[88:89]
    ds_read_b32 v251, v251 offset:4608
    s_mov_b64 exec, s[90:91]
    ds_read_b32 v255, v255 offset:4608
M_lk_4:
    s_mov_b64 exec, s[76:77]
    ds_read_b32 v227, v227 offset:4608
    s_mov_b64 exec, s[78:79]
    ds_read_b32 v231, v231 offset:4608
    s_mov_b64 exec, s[80:81]
    ds_read_b32 v235, v235 offset:4608
    s_mov_b64 exec, s[82:83]
    ds_read_b32 v239, v239 offset:4608
M_lk_3:
    s_mov_b64 exec, s[68:69]
    ds_read_b32 v211, v211 offset:4608
    s_mov_b64 exec, s[70:71]
    ds_read_b32 v215, v215 offset:4608
    s_mov_b64 exec, s[72:73]
    ds_read_b32 v219, v219 offset:4608
    s_mov_b64 exec, s[74:75]
    ds_read_b32 v223, v223 offset:4608
M_lk_2:
    s_mov_b64 exec, s[60:61]
    ds_read_b32 v195, v195 offset:4608
    s_mov_b64 exec, s[62:63]
    ds_read_b32 v199, v199 offset:4608
    s_mov_b64 exec, s[64:65]
    ds_read_b32 v203, v203 offset:4608
    s_mov_b64 exec, s[66:67]
    ds_read_b32 v207, v207 offset:4608
M_lk_1:
    s_mov_b64 exec, s[52:53]
    ds_read_b32 v179, v179 offset:4608
    s_mov_b64 exec, s[54:55]
    ds_read_b32 v183, v183 offset:4608
    s_mov_b64 exec, s[56:57]
    ds_read_b32 v187, v187 offset:4608
    s_mov_b64 exec, s[58:59]
    ds_read_b32 v191, v191 offset:4608
M_lk_0:
    s_mov_b64 exec, s[44:45]
    ds_read_b32 v163, v163 offset:4608
    s_mov_b64 exec, s[46:47]
    ds_read_b32 v167, v167 offset:4608
    s_mov_b64 exec, s[48:49]
    ds_read_b32 v171, v171 offset:4608
    s_mov_b64 exec, s[50:51]
    ds_read_b32 v175, v175 offset:4608
    s_mov_b64 exec, -1
    v_mov_b32 v25, v15
    v_mov_b32 v29, v15
    v_mov_b32 v33, v15
    v_mov_b32 v37, v15
    v_mov_b32 v41, v15
    v_mov_b32 v45, v15
    v_mov_b32 v19, v15
    v_mov_b32 v23, v15
    s_waitcnt lgkmcnt(0)
    v_readfirstlane_b32 s24, v20
    v_readfirstlane_b32 s21, v21
    s_cmp_eq_u32 s24, 0
    s_cbranch_scc1 M_go
    s_lshr_b32 s20, s20, 1
    s_max_u32 s20, s20, 1
    s_waitcnt vmcnt(0)
    s_barrier
    s_branch M_round
M_go:
    s_cmp_eq_u32 s41, 2
    s_cbranch_scc1 M_sc_1
    s_cmp_eq_u32 s41, 3
    s_cbranch_scc1 M_sc_2
    s_cmp_eq_u32 s41, 4
    s_cbranch_scc1 M_sc_3
    s_cmp_eq_u32 s41, 5
    s_cbranch_scc1 M_sc_4
M_sc_5:
    s_mov_b64 exec, s[84:85]
    v_lshl_add_u32 v243, v152, 3, v243
    ds_write_b16 v243, v242 offset:8
    ds_write_b64 v243, v[240:241] offset:160
    s_mov_b64 exec, s[86:87]
    v_lshl_add_u32 v247, v153, 3, v247
    ds_write_b16 v247, v246 offset:8
    ds_write_b64 v247, v[244:245] offset:160
    s_mov_b64 exec, s[88:89]
    v_lshl_add_u32 v251, v154, 3, v251
    ds_write_b16 v251, v250 offset:8
    ds_write_b64 v251, v[248:249] offset:160
    s_mov_b64 exec, s[90:91]
    v_lshl_add_u32 v255, v155, 3, v255
    ds_write_b16 v255, v254 offset:8
    ds_write_b64 v255, v[252:253] offset:160
M_sc_4:
    s_mov_b64 exec, s[76:77]
    v_lshl_add_u32 v227, v148, 3, v227
    ds_write_b16 v227, v226 offset:8
    ds_write_b64 v227, v[224:225] offset:160
    s_mov_b64 exec, s[78:79]
    v_lshl_add_u32 v231, v149, 3, v231
    ds_write_b16 v231, v230 offset:8
    ds_write_b64 v231, v[228:229] offset:160
    s_mov_b64 exec, s[80:81]
    v_lshl_add_u32 v235, v150, 3, v235
    ds_write_b16 v235, v234 offset:8
    ds_write_b64 v235, v[232:233] offset:160
    s_mov_b64 exec, s[82:83]
    v_lshl_add_u32 v239, v151, 3, v239
    ds_write_b16 v239, v238 offset:8
    ds_write_b64 v239, v[236:237] offset:160
M_sc_3:
    s_mov_b64 exec, s[68:69]
    v_lshl_add_u32 v211, v144, 3, v211
    ds_write_b16 v211, v210 offset:8
    ds_write_b64 v211, v[208:209] offset:160
    s_mov_b64 exec, s[70:71]
    v_lshl_add_u32 v215, v145, 3, v215
    ds_write_b16 v215, v214 offset:8
    ds_write_b64 v215, v[212:213] offset:160
    s_mov_b64 exec, s[72:73]
    v_lshl_add_u32 v219, v146, 3, v219
    ds_write_b16 v219, v218 offset:8
    ds_write_b64 v219, v[216:217] offset:160
    s_mov_b64 exec, s[74:75]
    v_lshl_add_u32 v223, v147, 3, v223
    ds_write_b16 v223, v222 offset:8
    ds_write_b64 v223, v[220:221] offset:160
M_sc_2:
    s_mov_b64 exec, s[60:61]
    v_lshl_add_u32 v195, v140, 3, v195
    ds_write_b16 v195, v194 offset:8
    ds_write_b64 v195, v[192:193] offset:160
    s_mov_b64 exec, s[62:63]
    v_lshl_add_u32 v199, v141, 3, v199
    ds_write_b16 v199, v198 offset:8
    ds_write_b64 v199, v[196:197] offset:160
    s_mov_b64 exec, s[64:65]
    v_lshl_add_u32 v203, v142, 3, v203
    ds_write_b16 v203, v202 offset:8
    ds_write_b64 v203, v[200:201] offset:160
    s_mov_b64 exec, s[66:67]
    v_lshl_add_u32 v207, v143, 3, v207
    ds_write_b16 v207, v206 offset:8
    ds_write_b64 v207, v[204:205] offset:160
M_sc_1:
    s_mov_b64 exec, s[52:53]
    v_lshl_add_u32 v179, v136, 3, v179
    ds_write_b16 v179, v178 offset:8
    ds_write_b64 v179, v[176:177] offset:160
    s_mov_b64 exec, s[54:55]
    v_lshl_add_u32 v183, v137, 3, v183
    ds_write_b16 v183, v182 offset:8
    ds_write_b64 v183, v[180:181] offset:160
    s_mov_b64 exec, s[56:57]
    v_lshl_add_u32 v187, v138, 3, v187
    ds_write_b16 v187, v186 offset:8
    ds_write_b64 v187, v[184:185] offset:160
    s_mov_b64 exec, s[58:59]
    v_lshl_add_u32 v191, v139, 3, v191
    ds_write_b16 v191, v190 offset:8
    ds_write_b64 v191, v[188:189] offset:160
M_sc_0:
    s_mov_b64 exec, s[44:45]
    v_lshl_add_u32 v163, v132, 3, v163
    ds_write_b16 v163, v162 offset:8
    ds_write_b64 v163, v[160:161] offset:160
    s_mov_b64 exec, s[46:47]
    v_lshl_add_u32 v167, v133, 3, v167
    ds_write_b16 v167, v166 offset:8
    ds_write_b64 v167, v[164:165] offset:160
    s_mov_b64 exec, s[48:49]
    v_lshl_add_u32 v171, v134, 3, v171
    ds_write_b16 v171, v170 offset:8
    ds_write_b64 v171, v[168:169] offset:160
    s_mov_b64 exec, s[50:51]
    v_lshl_add_u32 v175, v135, 3, v175
    ds_write_b16 v175, v174 offset:8
    ds_write_b64 v175, v[172:173] offset:160
    s_mov_b64 exec, -1
    s_waitcnt vmcnt(1) lgkmcnt(0)
    s_barrier
    ds_read_b32 v24, v2 offset:8
    ds_read_b32 v28, v2 offset:40
    ds_read_b32 v32, v2 offset:72
    ds_read_b32 v36, v2 offset:104
    ds_read_b32 v40, v2 offset:136
    ds_read_b32 v44, v2 offset:168
    ds_read_b64 v[26:27], v2 offset:160
    ds_read_b96 v[12:14], v2 offset:192
    ds_read_b96 v[16:18], v2 offset:224
    ds_read_b96 v[20:22], v2 offset:256
    v_mfma_f32_32x32x16_bf16 v[128:143], v[4:7], v[4:7], 0
    v_mfma_f32_32x32x16_bf16 v[144:159], v[4:7], v[4:7], 0
    v_mfma_f32_32x32x16_bf16 v[160:175], v[4:7], v[4:7], 0
    v_mfma_f32_32x32x16_bf16 v[176:191], v[4:7], v[4:7], 0
    v_mfma_f32_32x32x16_bf16 v[192:207], v[4:7], v[4:7], 0
    v_mfma_f32_32x32x16_bf16 v[208:223], v[4:7], v[4:7], 0
    v_mfma_f32_32x32x16_bf16 v[224:239], v[4:7], v[4:7], 0
    v_mfma_f32_32x32x16_bf16 v[240:255], v[4:7], v[4:7], 0
    s_waitcnt lgkmcnt(3)
    v_perm_b32 v4, v27, v26, v8
    v_perm_b32 v5, v27, v26, v9
    buffer_load_dwordx4 v[24:27], v[24:25], s[4:7], 0 idxen offen
    buffer_load_dwordx4 v[28:31], v[28:29], s[4:7], 0 idxen offen
    buffer_load_dwordx4 v[32:35], v[32:33], s[4:7], 0 idxen offen
    buffer_load_dwordx4 v[36:39], v[36:37], s[4:7], 0 idxen offen
    buffer_load_dwordx4 v[40:43], v[40:41], s[4:7], 0 idxen offen
    buffer_load_dwordx4 v[44:47], v[44:45], s[4:7], 0 idxen offen
    s_mov_b32 s23, 0
    s_setprio 2
    s_branch M_PE0
M_B0_0:
    s_sub_u32 s28, s28, 1
    s_cbranch_scc1 M_B1_0
    s_waitcnt vmcnt(5) lgkmcnt(2)
    v_smfmac_f32_32x32x16_bf16 v[48:63], v[4:5], v[24:27], v10
    buffer_load_dwordx4 v[24:27], v[14:15], s[4:7], 0 idxen offen
    v_perm_b32 v4, v13, v12, v8
    v_perm_b32 v5, v13, v12, v9
    ds_read_b96 v[12:14], v2 offset:288
M_B0_1:
    s_sub_u32 s28, s28, 1
    s_cbranch_scc1 M_B1_1
    s_waitcnt vmcnt(5) lgkmcnt(2)
    v_smfmac_f32_32x32x16_bf16 v[48:63], v[4:5], v[28:31], v10
    buffer_load_dwordx4 v[28:31], v[18:19], s[4:7], 0 idxen offen
    v_perm_b32 v4, v17, v16, v8
    v_perm_b32 v5, v17, v16, v9
    ds_read_b96 v[16:18], v2 offset:320
M_B0_2:
    s_sub_u32 s28, s28, 1
    s_cbranch_scc1 M_B1_2
    s_waitcnt vmcnt(5) lgkmcnt(2)
    v_smfmac_f32_32x32x16_bf16 v[48:63], v[4:5], v[32:35], v10
    buffer_load_dwordx4 v[32:35], v[22:23], s[4:7], 0 idxen offen
    v_perm_b32 v4, v21, v20, v8
    v_perm_b32 v5, v21, v20, v9
    ds_read_b96 v[20:22], v2 offset:352
M_B0_3:
    s_sub_u32 s28, s28, 1
    s_cbranch_scc1 M_B1_3
    s_waitcnt vmcnt(5) lgkmcnt(2)
    v_smfmac_f32_32x32x16_bf16 v[48:63], v[4:5], v[36:39], v10
    buffer_load_dwordx4 v[36:39], v[14:15], s[4:7], 0 idxen offen
    v_perm_b32 v4, v13, v12, v8
    v_perm_b32 v5, v13, v12, v9
    ds_read_b96 v[12:14], v2 offset:384
M_B0_4:
    s_sub_u32 s28, s28, 1
    s_cbranch_scc1 M_B1_4
    s_waitcnt vmcnt(5) lgkmcnt(2)
    v_smfmac_f32_32x32x16_bf16 v[48:63], v[4:5], v[40:43], v10
    buffer_load_dwordx4 v[40:43], v[18:19], s[4:7], 0 idxen offen
    v_perm_b32 v4, v17, v16, v8
    v_perm_b32 v5, v17, v16, v9
    ds_read_b96 v[16:18], v2 offset:416
M_B0_5:
    s_sub_u32 s28, s28, 1
    s_cbranch_scc1 M_B1_5
    s_waitcnt vmcnt(5) lgkmcnt(2)
    v_smfmac_f32_32x32x16_bf16 v[48:63], v[4:5], v[44:47], v10
    buffer_load_dwordx4 v[44:47], v[22:23], s[4:7], 0 idxen offen
    v_perm_b32 v4, v21, v20, v8
    v_perm_b32 v5, v21, v20, v9
    ds_read_b96 v[20:22], v2 offset:448
    v_add_u32 v2, 192, v2
    s_branch M_B0_0
M_B1_0:
    s_sub_u32 s29, s29, 1
    s_cbranch_scc1 M_B2_0
    s_waitcnt vmcnt(5) lgkmcnt(2)
    v_smfmac_f32_32x32x16_bf16 v[64:79], v[4:5], v[24:27], v10
    buffer_load_dwordx4 v[24:27], v[14:15], s[4:7], 0 idxen offen
    v_perm_b32 v4, v13, v12, v8
    v_perm_b32 v5, v13, v12, v9
    ds_read_b96 v[12:14], v2 offset:288
M_B1_1:
    s_sub_u32 s29, s29, 1
    s_cbranch_scc1 M_B2_1
    s_waitcnt vmcnt(5) lgkmcnt(2)
    v_smfmac_f32_32x32x16_bf16 v[64:79], v[4:5], v[28:31], v10
    buffer_load_dwordx4 v[28:31], v[18:19], s[4:7], 0 idxen offen
    v_perm_b32 v4, v17, v16, v8
    v_perm_b32 v5, v17, v16, v9
    ds_read_b96 v[16:18], v2 offset:320
M_B1_2:
    s_sub_u32 s29, s29, 1
    s_cbranch_scc1 M_B2_2
    s_waitcnt vmcnt(5) lgkmcnt(2)
    v_smfmac_f32_32x32x16_bf16 v[64:79], v[4:5], v[32:35], v10
    buffer_load_dwordx4 v[32:35], v[22:23], s[4:7], 0 idxen offen
    v_perm_b32 v4, v21, v20, v8
    v_perm_b32 v5, v21, v20, v9
    ds_read_b96 v[20:22], v2 offset:352
M_B1_3:
    s_sub_u32 s29, s29, 1
    s_cbranch_scc1 M_B2_3
    s_waitcnt vmcnt(5) lgkmcnt(2)
    v_smfmac_f32_32x32x16_bf16 v[64:79], v[4:5], v[36:39], v10
    buffer_load_dwordx4 v[36:39], v[14:15], s[4:7], 0 idxen offen
    v_perm_b32 v4, v13, v12, v8
    v_perm_b32 v5, v13, v12, v9
    ds_read_b96 v[12:14], v2 offset:384
M_B1_4:
    s_sub_u32 s29, s29, 1
    s_cbranch_scc1 M_B2_4
    s_waitcnt vmcnt(5) lgkmcnt(2)
    v_smfmac_f32_32x32x16_bf16 v[64:79], v[4:5], v[40:43], v10
    buffer_load_dwordx4 v[40:43], v[18:19], s[4:7], 0 idxen offen
    v_perm_b32 v4, v17, v16, v8
    v_perm_b32 v5, v17, v16, v9
    ds_read_b96 v[16:18], v2 offset:416
M_B1_5:
    s_sub_u32 s29, s29, 1
    s_cbranch_scc1 M_B2_5
    s_waitcnt vmcnt(5) lgkmcnt(2)
    v_smfmac_f32_32x32x16_bf16 v[64:79], v[4:5], v[44:47], v10
    buffer_load_dwordx4 v[44:47], v[22:23], s[4:7], 0 idxen offen
    v_perm_b32 v4, v21, v20, v8
    v_perm_b32 v5, v21, v20, v9
    ds_read_b96 v[20:22], v2 offset:448
    v_add_u32 v2, 192, v2
    s_branch M_B1_0
M_B2_0:
    s_sub_u32 s30, s30, 1
    s_cbranch_scc1 M_B3_0
    s_waitcnt vmcnt(5) lgkmcnt(2)
    v_smfmac_f32_32x32x16_bf16 v[80:95], v[4:5], v[24:27], v10
    buffer_load_dwordx4 v[24:27], v[14:15], s[4:7], 0 idxen offen
    v_perm_b32 v4, v13, v12, v8
    v_perm_b32 v5, v13, v12, v9
    ds_read_b96 v[12:14], v2 offset:288
M_B2_1:
    s_sub_u32 s30, s30, 1
    s_cbranch_scc1 M_B3_1
    s_waitcnt vmcnt(5) lgkmcnt(2)
    v_smfmac_f32_32x32x16_bf16 v[80:95], v[4:5], v[28:31], v10
    buffer_load_dwordx4 v[28:31], v[18:19], s[4:7], 0 idxen offen
    v_perm_b32 v4, v17, v16, v8
    v_perm_b32 v5, v17, v16, v9
    ds_read_b96 v[16:18], v2 offset:320
M_B2_2:
    s_sub_u32 s30, s30, 1
    s_cbranch_scc1 M_B3_2
    s_waitcnt vmcnt(5) lgkmcnt(2)
    v_smfmac_f32_32x32x16_bf16 v[80:95], v[4:5], v[32:35], v10
    buffer_load_dwordx4 v[32:35], v[22:23], s[4:7], 0 idxen offen
    v_perm_b32 v4, v21, v20, v8
    v_perm_b32 v5, v21, v20, v9
    ds_read_b96 v[20:22], v2 offset:352
M_B2_3:
    s_sub_u32 s30, s30, 1
    s_cbranch_scc1 M_B3_3
    s_waitcnt vmcnt(5) lgkmcnt(2)
    v_smfmac_f32_32x32x16_bf16 v[80:95], v[4:5], v[36:39], v10
    buffer_load_dwordx4 v[36:39], v[14:15], s[4:7], 0 idxen offen
    v_perm_b32 v4, v13, v12, v8
    v_perm_b32 v5, v13, v12, v9
    ds_read_b96 v[12:14], v2 offset:384
M_B2_4:
    s_sub_u32 s30, s30, 1
    s_cbranch_scc1 M_B3_4
    s_waitcnt vmcnt(5) lgkmcnt(2)
    v_smfmac_f32_32x32x16_bf16 v[80:95], v[4:5], v[40:43], v10
    buffer_load_dwordx4 v[40:43], v[18:19], s[4:7], 0 idxen offen
    v_perm_b32 v4, v17, v16, v8
    v_perm_b32 v5, v17, v16, v9
    ds_read_b96 v[16:18], v2 offset:416
M_B2_5:
    s_sub_u32 s30, s30, 1
    s_cbranch_scc1 M_B3_5
    s_waitcnt vmcnt(5) lgkmcnt(2)
    v_smfmac_f32_32x32x16_bf16 v[80:95], v[4:5], v[44:47], v10
    buffer_load_dwordx4 v[44:47], v[22:23], s[4:7], 0 idxen offen
    v_perm_b32 v4, v21, v20, v8
    v_perm_b32 v5, v21, v20, v9
    ds_read_b96 v[20:22], v2 offset:448
    v_add_u32 v2, 192, v2
    s_branch M_B2_0
M_B3_0:
    s_sub_u32 s31, s31, 1
    s_cbranch_scc1 M_B4_0
    s_waitcnt vmcnt(5) lgkmcnt(2)
    v_smfmac_f32_32x32x16_bf16 v[96:111], v[4:5], v[24:27], v10
    buffer_load_dwordx4 v[24:27], v[14:15], s[4:7], 0 idxen offen
    v_perm_b32 v4, v13, v12, v8
    v_perm_b32 v5, v13, v12, v9
    ds_read_b96 v[12:14], v2 offset:288
M_B3_1:
    s_sub_u32 s31, s31, 1
    s_cbranch_scc1 M_B4_1
    s_waitcnt vmcnt(5) lgkmcnt(2)
    v_smfmac_f32_32x32x16_bf16 v[96:111], v[4:5], v[28:31], v10
    buffer_load_dwordx4 v[28:31], v[18:19], s[4:7], 0 idxen offen
    v_perm_b32 v4, v17, v16, v8
    v_perm_b32 v5, v17, v16, v9
    ds_read_b96 v[16:18], v2 offset:320
M_B3_2:
    s_sub_u32 s31, s31, 1
    s_cbranch_scc1 M_B4_2
    s_waitcnt vmcnt(5) lgkmcnt(2)
    v_smfmac_f32_32x32x16_bf16 v[96:111], v[4:5], v[32:35], v10
    buffer_load_dwordx4 v[32:35], v[22:23], s[4:7], 0 idxen offen
    v_perm_b32 v4, v21, v20, v8
    v_perm_b32 v5, v21, v20, v9
    ds_read_b96 v[20:22], v2 offset:352
M_B3_3:
    s_sub_u32 s31, s31, 1
    s_cbranch_scc1 M_B4_3
    s_waitcnt vmcnt(5) lgkmcnt(2)
    v_smfmac_f32_32x32x16_bf16 v[96:111], v[4:5], v[36:39], v10
    buffer_load_dwordx4 v[36:39], v[14:15], s[4:7], 0 idxen offen
    v_perm_b32 v4, v13, v12, v8
    v_perm_b32 v5, v13, v12, v9
    ds_read_b96 v[12:14], v2 offset:384
M_B3_4:
    s_sub_u32 s31, s31, 1
    s_cbranch_scc1 M_B4_4
    s_waitcnt vmcnt(5) lgkmcnt(2)
    v_smfmac_f32_32x32x16_bf16 v[96:111], v[4:5], v[40:43], v10
    buffer_load_dwordx4 v[40:43], v[18:19], s[4:7], 0 idxen offen
    v_perm_b32 v4, v17, v16, v8
    v_perm_b32 v5, v17, v16, v9
    ds_read_b96 v[16:18], v2 offset:416
M_B3_5:
    s_sub_u32 s31, s31, 1
    s_cbranch_scc1 M_B4_5
    s_waitcnt vmcnt(5) lgkmcnt(2)
    v_smfmac_f32_32x32x16_bf16 v[96:111], v[4:5], v[44:47], v10
    buffer_load_dwordx4 v[44:47], v[22:23], s[4:7], 0 idxen offen
    v_perm_b32 v4, v21, v20, v8
    v_perm_b32 v5, v21, v20, v9
    ds_read_b96 v[20:22], v2 offset:448
    v_add_u32 v2, 192, v2
    s_branch M_B3_0
M_B4_0:
    s_sub_u32 s32, s32, 1
    s_cbranch_scc1 M_B5_0
    s_waitcnt vmcnt(5) lgkmcnt(2)
    v_smfmac_f32_32x32x16_bf16 v[112:127], v[4:5], v[24:27], v10
    buffer_load_dwordx4 v[24:27], v[14:15], s[4:7], 0 idxen offen
    v_perm_b32 v4, v13, v12, v8
    v_perm_b32 v5, v13, v12, v9
    ds_read_b96 v[12:14], v2 offset:288
M_B4_1:
    s_sub_u32 s32, s32, 1
    s_cbranch_scc1 M_B5_1
    s_waitcnt vmcnt(5) lgkmcnt(2)
    v_smfmac_f32_32x32x16_bf16 v[112:127], v[4:5], v[28:31], v10
    buffer_load_dwordx4 v[28:31], v[18:19], s[4:7], 0 idxen offen
    v_perm_b32 v4, v17, v16, v8
    v_perm_b32 v5, v17, v16, v9
    ds_read_b96 v[16:18], v2 offset:320
M_B4_2:
    s_sub_u32 s32, s32, 1
    s_cbranch_scc1 M_B5_2
    s_waitcnt vmcnt(5) lgkmcnt(2)
    v_smfmac_f32_32x32x16_bf16 v[112:127], v[4:5], v[32:35], v10
    buffer_load_dwordx4 v[32:35], v[22:23], s[4:7], 0 idxen offen
    v_perm_b32 v4, v21, v20, v8
    v_perm_b32 v5, v21, v20, v9
    ds_read_b96 v[20:22], v2 offset:352
M_B4_3:
    s_sub_u32 s32, s32, 1
    s_cbranch_scc1 M_B5_3
    s_waitcnt vmcnt(5) lgkmcnt(2)
    v_smfmac_f32_32x32x16_bf16 v[112:127], v[4:5], v[36:39], v10
    buffer_load_dwordx4 v[36:39], v[14:15], s[4:7], 0 idxen offen
    v_perm_b32 v4, v13, v12, v8
    v_perm_b32 v5, v13, v12, v9
    ds_read_b96 v[12:14], v2 offset:384
M_B4_4:
    s_sub_u32 s32, s32, 1
    s_cbranch_scc1 M_B5_4
    s_waitcnt vmcnt(5) lgkmcnt(2)
    v_smfmac_f32_32x32x16_bf16 v[112:127], v[4:5], v[40:43], v10
    buffer_load_dwordx4 v[40:43], v[18:19], s[4:7], 0 idxen offen
    v_perm_b32 v4, v17, v16, v8
    v_perm_b32 v5, v17, v16, v9
    ds_read_b96 v[16:18], v2 offset:416
M_B4_5:
    s_sub_u32 s32, s32, 1
    s_cbranch_scc1 M_B5_5
    s_waitcnt vmcnt(5) lgkmcnt(2)
    v_smfmac_f32_32x32x16_bf16 v[112:127], v[4:5], v[44:47], v10
    buffer_load_dwordx4 v[44:47], v[22:23], s[4:7], 0 idxen offen
    v_perm_b32 v4, v21, v20, v8
    v_perm_b32 v5, v21, v20, v9
    ds_read_b96 v[20:22], v2 offset:448
    v_add_u32 v2, 192, v2
    s_branch M_B4_0
M_B5_0:
    s_sub_u32 s33, s33, 1
    s_cbranch_scc1 M_B6_0
    s_waitcnt vmcnt(5) lgkmcnt(2)
    v_smfmac_f32_32x32x16_bf16 v[128:143], v[4:5], v[24:27], v10
    buffer_load_dwordx4 v[24:27], v[14:15], s[4:7], 0 idxen offen
    v_perm_b32 v4, v13, v12, v8
    v_perm_b32 v5, v13, v12, v9
    ds_read_b96 v[12:14], v2 offset:288
M_B5_1:
    s_sub_u32 s33, s33, 1
    s_cbranch_scc1 M_B6_1
    s_waitcnt vmcnt(5) lgkmcnt(2)
    v_smfmac_f32_32x32x16_bf16 v[128:143], v[4:5], v[28:31], v10
    buffer_load_dwordx4 v[28:31], v[18:19], s[4:7], 0 idxen offen
    v_perm_b32 v4, v17, v16, v8
    v_perm_b32 v5, v17, v16, v9
    ds_read_b96 v[16:18], v2 offset:320
M_B5_2:
    s_sub_u32 s33, s33, 1
    s_cbranch_scc1 M_B6_2
    s_waitcnt vmcnt(5) lgkmcnt(2)
    v_smfmac_f32_32x32x16_bf16 v[128:143], v[4:5], v[32:35], v10
    buffer_load_dwordx4 v[32:35], v[22:23], s[4:7], 0 idxen offen
    v_perm_b32 v4, v21, v20, v8
    v_perm_b32 v5, v21, v20, v9
    ds_read_b96 v[20:22], v2 offset:352
M_B5_3:
    s_sub_u32 s33, s33, 1
    s_cbranch_scc1 M_B6_3
    s_waitcnt vmcnt(5) lgkmcnt(2)
    v_smfmac_f32_32x32x16_bf16 v[128:143], v[4:5], v[36:39], v10
    buffer_load_dwordx4 v[36:39], v[14:15], s[4:7], 0 idxen offen
    v_perm_b32 v4, v13, v12, v8
    v_perm_b32 v5, v13, v12, v9
    ds_read_b96 v[12:14], v2 offset:384
M_B5_4:
    s_sub_u32 s33, s33, 1
    s_cbranch_scc1 M_B6_4
    s_waitcnt vmcnt(5) lgkmcnt(2)
    v_smfmac_f32_32x32x16_bf16 v[128:143], v[4:5], v[40:43], v10
    buffer_load_dwordx4 v[40:43], v[18:19], s[4:7], 0 idxen offen
    v_perm_b32 v4, v17, v16, v8
    v_perm_b32 v5, v17, v16, v9
    ds_read_b96 v[16:18], v2 offset:416
M_B5_5:
    s_sub_u32 s33, s33, 1
    s_cbranch_scc1 M_B6_5
    s_waitcnt vmcnt(5) lgkmcnt(2)
    v_smfmac_f32_32x32x16_bf16 v[128:143], v[4:5], v[44:47], v10
    buffer_load_dwordx4 v[44:47], v[22:23], s[4:7], 0 idxen offen
    v_perm_b32 v4, v21, v20, v8
    v_perm_b32 v5, v21, v20, v9
    ds_read_b96 v[20:22], v2 offset:448
    v_add_u32 v2, 192, v2
    s_branch M_B5_0
M_B6_0:
    s_sub_u32 s34, s34, 1
    s_cbranch_scc1 M_B7_0
    s_waitcnt vmcnt(5) lgkmcnt(2)
    v_smfmac_f32_32x32x16_bf16 v[144:159], v[4:5], v[24:27], v10
    buffer_load_dwordx4 v[24:27], v[14:15], s[4:7], 0 idxen offen
    v_perm_b32 v4, v13, v12, v8
    v_perm_b32 v5, v13, v12, v9
    ds_read_b96 v[12:14], v2 offset:288
M_B6_1:
    s_sub_u32 s34, s34, 1
    s_cbranch_scc1 M_B7_1
    s_waitcnt vmcnt(5) lgkmcnt(2)
    v_smfmac_f32_32x32x16_bf16 v[144:159], v[4:5], v[28:31], v10
    buffer_load_dwordx4 v[28:31], v[18:19], s[4:7], 0 idxen offen
    v_perm_b32 v4, v17, v16, v8
    v_perm_b32 v5, v17, v16, v9
    ds_read_b96 v[16:18], v2 offset:320
M_B6_2:
    s_sub_u32 s34, s34, 1
    s_cbranch_scc1 M_B7_2
    s_waitcnt vmcnt(5) lgkmcnt(2)
    v_smfmac_f32_32x32x16_bf16 v[144:159], v[4:5], v[32:35], v10
    buffer_load_dwordx4 v[32:35], v[22:23], s[4:7], 0 idxen offen
    v_perm_b32 v4, v21, v20, v8
    v_perm_b32 v5, v21, v20, v9
    ds_read_b96 v[20:22], v2 offset:352
M_B6_3:
    s_sub_u32 s34, s34, 1
    s_cbranch_scc1 M_B7_3
    s_waitcnt vmcnt(5) lgkmcnt(2)
    v_smfmac_f32_32x32x16_bf16 v[144:159], v[4:5], v[36:39], v10
    buffer_load_dwordx4 v[36:39], v[14:15], s[4:7], 0 idxen offen
    v_perm_b32 v4, v13, v12, v8
    v_perm_b32 v5, v13, v12, v9
    ds_read_b96 v[12:14], v2 offset:384
M_B6_4:
    s_sub_u32 s34, s34, 1
    s_cbranch_scc1 M_B7_4
    s_waitcnt vmcnt(5) lgkmcnt(2)
    v_smfmac_f32_32x32x16_bf16 v[144:159], v[4:5], v[40:43], v10
    buffer_load_dwordx4 v[40:43], v[18:19], s[4:7], 0 idxen offen
    v_perm_b32 v4, v17, v16, v8
    v_perm_b32 v5, v17, v16, v9
    ds_read_b96 v[16:18], v2 offset:416
M_B6_5:
    s_sub_u32 s34, s34, 1
    s_cbranch_scc1 M_B7_5
    s_waitcnt vmcnt(5) lgkmcnt(2)
    v_smfmac_f32_32x32x16_bf16 v[144:159], v[4:5], v[44:47], v10
    buffer_load_dwordx4 v[44:47], v[22:23], s[4:7], 0 idxen offen
    v_perm_b32 v4, v21, v20, v8
    v_perm_b32 v5, v21, v20, v9
    ds_read_b96 v[20:22], v2 offset:448
    v_add_u32 v2, 192, v2
    s_branch M_B6_0
M_B7_0:
    s_sub_u32 s35, s35, 1
    s_cbranch_scc1 M_B8_0
    s_waitcnt vmcnt(5) lgkmcnt(2)
    v_smfmac_f32_32x32x16_bf16 v[160:175], v[4:5], v[24:27], v10
    buffer_load_dwordx4 v[24:27], v[14:15], s[4:7], 0 idxen offen
    v_perm_b32 v4, v13, v12, v8
    v_perm_b32 v5, v13, v12, v9
    ds_read_b96 v[12:14], v2 offset:288
M_B7_1:
    s_sub_u32 s35, s35, 1
    s_cbranch_scc1 M_B8_1
    s_waitcnt vmcnt(5) lgkmcnt(2)
    v_smfmac_f32_32x32x16_bf16 v[160:175], v[4:5], v[28:31], v10
    buffer_load_dwordx4 v[28:31], v[18:19], s[4:7], 0 idxen offen
    v_perm_b32 v4, v17, v16, v8
    v_perm_b32 v5, v17, v16, v9
    ds_read_b96 v[16:18], v2 offset:320
M_B7_2:
    s_sub_u32 s35, s35, 1
    s_cbranch_scc1 M_B8_2
    s_waitcnt vmcnt(5) lgkmcnt(2)
    v_smfmac_f32_32x32x16_bf16 v[160:175], v[4:5], v[32:35], v10
    buffer_load_dwordx4 v[32:35], v[22:23], s[4:7], 0 idxen offen
    v_perm_b32 v4, v21, v20, v8
    v_perm_b32 v5, v21, v20, v9
    ds_read_b96 v[20:22], v2 offset:352
M_B7_3:
    s_sub_u32 s35, s35, 1
    s_cbranch_scc1 M_B8_3
    s_waitcnt vmcnt(5) lgkmcnt(2)
    v_smfmac_f32_32x32x16_bf16 v[160:175], v[4:5], v[36:39], v10
    buffer_load_dwordx4 v[36:39], v[14:15], s[4:7], 0 idxen offen
    v_perm_b32 v4, v13, v12, v8
    v_perm_b32 v5, v13, v12, v9
    ds_read_b96 v[12:14], v2 offset:384
M_B7_4:
    s_sub_u32 s35, s35, 1
    s_cbranch_scc1 M_B8_4
    s_waitcnt vmcnt(5) lgkmcnt(2)
    v_smfmac_f32_32x32x16_bf16 v[160:175], v[4:5], v[40:43], v10
    buffer_load_dwordx4 v[40:43], v[18:19], s[4:7], 0 idxen offen
    v_perm_b32 v4, v17, v16, v8
    v_perm_b32 v5, v17, v16, v9
    ds_read_b96 v[16:18], v2 offset:416
M_B7_5:
    s_sub_u32 s35, s35, 1
    s_cbranch_scc1 M_B8_5
    s_waitcnt vmcnt(5) lgkmcnt(2)
    v_smfmac_f32_32x32x16_bf16 v[160:175], v[4:5], v[44:47], v10
    buffer_load_dwordx4 v[44:47], v[22:23], s[4:7], 0 idxen offen
    v_perm_b32 v4, v21, v20, v8
    v_perm_b32 v5, v21, v20, v9
    ds_read_b96 v[20:22], v2 offset:448
    v_add_u32 v2, 192, v2
    s_branch M_B7_0
M_B8_0:
    s_sub_u32 s36, s36, 1
    s_cbranch_scc1 M_B9_0
    s_waitcnt vmcnt(5) lgkmcnt(2)
    v_smfmac_f32_32x32x16_bf16 v[176:191], v[4:5], v[24:27], v10
    buffer_load_dwordx4 v[24:27], v[14:15], s[4:7], 0 idxen offen
    v_perm_b32 v4, v13, v12, v8
    v_perm_b32 v5, v13, v12, v9
    ds_read_b96 v[12:14], v2 offset:288
M_B8_1:
    s_sub_u32 s36, s36, 1
    s_cbranch_scc1 M_B9_1
    s_waitcnt vmcnt(5) lgkmcnt(2)
    v_smfmac_f32_32x32x16_bf16 v[176:191], v[4:5], v[28:31], v10
    buffer_load_dwordx4 v[28:31], v[18:19], s[4:7], 0 idxen offen
    v_perm_b32 v4, v17, v16, v8
    v_perm_b32 v5, v17, v16, v9
    ds_read_b96 v[16:18], v2 offset:320
M_B8_2:
    s_sub_u32 s36, s36, 1
    s_cbranch_scc1 M_B9_2
    s_waitcnt vmcnt(5) lgkmcnt(2)
    v_smfmac_f32_32x32x16_bf16 v[176:191], v[4:5], v[32:35], v10
    buffer_load_dwordx4 v[32:35], v[22:23], s[4:7], 0 idxen offen
    v_perm_b32 v4, v21, v20, v8
    v_perm_b32 v5, v21, v20, v9
    ds_read_b96 v[20:22], v2 offset:352
M_B8_3:
    s_sub_u32 s36, s36, 1
    s_cbranch_scc1 M_B9_3
    s_waitcnt vmcnt(5) lgkmcnt(2)
    v_smfmac_f32_32x32x16_bf16 v[176:191], v[4:5], v[36:39], v10
    buffer_load_dwordx4 v[36:39], v[14:15], s[4:7], 0 idxen offen
    v_perm_b32 v4, v13, v12, v8
    v_perm_b32 v5, v13, v12, v9
    ds_read_b96 v[12:14], v2 offset:384
M_B8_4:
    s_sub_u32 s36, s36, 1
    s_cbranch_scc1 M_B9_4
    s_waitcnt vmcnt(5) lgkmcnt(2)
    v_smfmac_f32_32x32x16_bf16 v[176:191], v[4:5], v[40:43], v10
    buffer_load_dwordx4 v[40:43], v[18:19], s[4:7], 0 idxen offen
    v_perm_b32 v4, v17, v16, v8
    v_perm_b32 v5, v17, v16, v9
    ds_read_b96 v[16:18], v2 offset:416
M_B8_5:
    s_sub_u32 s36, s36, 1
    s_cbranch_scc1 M_B9_5
    s_waitcnt vmcnt(5) lgkmcnt(2)
    v_smfmac_f32_32x32x16_bf16 v[176:191], v[4:5], v[44:47], v10
    buffer_load_dwordx4 v[44:47], v[22:23], s[4:7], 0 idxen offen
    v_perm_b32 v4, v21, v20, v8
    v_perm_b32 v5, v21, v20, v9
    ds_read_b96 v[20:22], v2 offset:448
    v_add_u32 v2, 192, v2
    s_branch M_B8_0
M_B9_0:
    s_sub_u32 s37, s37, 1
    s_cbranch_scc1 M_B10_0
    s_waitcnt vmcnt(5) lgkmcnt(2)
    v_smfmac_f32_32x32x16_bf16 v[192:207], v[4:5], v[24:27], v10
    buffer_load_dwordx4 v[24:27], v[14:15], s[4:7], 0 idxen offen
    v_perm_b32 v4, v13, v12, v8
    v_perm_b32 v5, v13, v12, v9
    ds_read_b96 v[12:14], v2 offset:288
M_B9_1:
    s_sub_u32 s37, s37, 1
    s_cbranch_scc1 M_B10_1
    s_waitcnt vmcnt(5) lgkmcnt(2)
    v_smfmac_f32_32x32x16_bf16 v[192:207], v[4:5], v[28:31], v10
    buffer_load_dwordx4 v[28:31], v[18:19], s[4:7], 0 idxen offen
    v_perm_b32 v4, v17, v16, v8
    v_perm_b32 v5, v17, v16, v9
    ds_read_b96 v[16:18], v2 offset:320
M_B9_2:
    s_sub_u32 s37, s37, 1
    s_cbranch_scc1 M_B10_2
    s_waitcnt vmcnt(5) lgkmcnt(2)
    v_smfmac_f32_32x32x16_bf16 v[192:207], v[4:5], v[32:35], v10
    buffer_load_dwordx4 v[32:35], v[22:23], s[4:7], 0 idxen offen
    v_perm_b32 v4, v21, v20, v8
    v_perm_b32 v5, v21, v20, v9
    ds_read_b96 v[20:22], v2 offset:352
M_B9_3:
    s_sub_u32 s37, s37, 1
    s_cbranch_scc1 M_B10_3
    s_waitcnt vmcnt(5) lgkmcnt(2)
    v_smfmac_f32_32x32x16_bf16 v[192:207], v[4:5], v[36:39], v10
    buffer_load_dwordx4 v[36:39], v[14:15], s[4:7], 0 idxen offen
    v_perm_b32 v4, v13, v12, v8
    v_perm_b32 v5, v13, v12, v9
    ds_read_b96 v[12:14], v2 offset:384
M_B9_4:
    s_sub_u32 s37, s37, 1
    s_cbranch_scc1 M_B10_4
    s_waitcnt vmcnt(5) lgkmcnt(2)
    v_smfmac_f32_32x32x16_bf16 v[192:207], v[4:5], v[40:43], v10
    buffer_load_dwordx4 v[40:43], v[18:19], s[4:7], 0 idxen offen
    v_perm_b32 v4, v17, v16, v8
    v_perm_b32 v5, v17, v16, v9
    ds_read_b96 v[16:18], v2 offset:416
M_B9_5:
    s_sub_u32 s37, s37, 1
    s_cbranch_scc1 M_B10_5
    s_waitcnt vmcnt(5) lgkmcnt(2)
    v_smfmac_f32_32x32x16_bf16 v[192:207], v[4:5], v[44:47], v10
    buffer_load_dwordx4 v[44:47], v[22:23], s[4:7], 0 idxen offen
    v_perm_b32 v4, v21, v20, v8
    v_perm_b32 v5, v21, v20, v9
    ds_read_b96 v[20:22], v2 offset:448
    v_add_u32 v2, 192, v2
    s_branch M_B9_0
M_B10_0:
    s_sub_u32 s38, s38, 1
    s_cbranch_scc1 M_B11_0
    s_waitcnt vmcnt(5) lgkmcnt(2)
    v_smfmac_f32_32x32x16_bf16 v[208:223], v[4:5], v[24:27], v10
    buffer_load_dwordx4 v[24:27], v[14:15], s[4:7], 0 idxen offen
    v_perm_b32 v4, v13, v12, v8
    v_perm_b32 v5, v13, v12, v9
    ds_read_b96 v[12:14], v2 offset:288
M_B10_1:
    s_sub_u32 s38, s38, 1
    s_cbranch_scc1 M_B11_1
    s_waitcnt vmcnt(5) lgkmcnt(2)
    v_smfmac_f32_32x32x16_bf16 v[208:223], v[4:5], v[28:31], v10
    buffer_load_dwordx4 v[28:31], v[18:19], s[4:7], 0 idxen offen
    v_perm_b32 v4, v17, v16, v8
    v_perm_b32 v5, v17, v16, v9
    ds_read_b96 v[16:18], v2 offset:320
M_B10_2:
    s_sub_u32 s38, s38, 1
    s_cbranch_scc1 M_B11_2
    s_waitcnt vmcnt(5) lgkmcnt(2)
    v_smfmac_f32_32x32x16_bf16 v[208:223], v[4:5], v[32:35], v10
    buffer_load_dwordx4 v[32:35], v[22:23], s[4:7], 0 idxen offen
    v_perm_b32 v4, v21, v20, v8
    v_perm_b32 v5, v21, v20, v9
    ds_read_b96 v[20:22], v2 offset:352
M_B10_3:
    s_sub_u32 s38, s38, 1
    s_cbranch_scc1 M_B11_3
    s_waitcnt vmcnt(5) lgkmcnt(2)
    v_smfmac_f32_32x32x16_bf16 v[208:223], v[4:5], v[36:39], v10
    buffer_load_dwordx4 v[36:39], v[14:15], s[4:7], 0 idxen offen
    v_perm_b32 v4, v13, v12, v8
    v_perm_b32 v5, v13, v12, v9
    ds_read_b96 v[12:14], v2 offset:384
M_B10_4:
    s_sub_u32 s38, s38, 1
    s_cbranch_scc1 M_B11_4
    s_waitcnt vmcnt(5) lgkmcnt(2)
    v_smfmac_f32_32x32x16_bf16 v[208:223], v[4:5], v[40:43], v10
    buffer_load_dwordx4 v[40:43], v[18:19], s[4:7], 0 idxen offen
    v_perm_b32 v4, v17, v16, v8
    v_perm_b32 v5, v17, v16, v9
    ds_read_b96 v[16:18], v2 offset:416
M_B10_5:
    s_sub_u32 s38, s38, 1
    s_cbranch_scc1 M_B11_5
    s_waitcnt vmcnt(5) lgkmcnt(2)
    v_smfmac_f32_32x32x16_bf16 v[208:223], v[4:5], v[44:47], v10
    buffer_load_dwordx4 v[44:47], v[22:23], s[4:7], 0 idxen offen
    v_perm_b32 v4, v21, v20, v8
    v_perm_b32 v5, v21, v20, v9
    ds_read_b96 v[20:22], v2 offset:448
    v_add_u32 v2, 192, v2
    s_branch M_B10_0
M_B11_0:
    s_sub_u32 s39, s39, 1
    s_cbranch_scc1 M_B12_0
    s_waitcnt vmcnt(5) lgkmcnt(2)
    v_smfmac_f32_32x32x16_bf16 v[224:239], v[4:5], v[24:27], v10
    buffer_load_dwordx4 v[24:27], v[14:15], s[4:7], 0 idxen offen
    v_perm_b32 v4, v13, v12, v8
    v_perm_b32 v5, v13, v12, v9
    ds_read_b96 v[12:14], v2 offset:288
M_B11_1:
    s_sub_u32 s39, s39, 1
    s_cbranch_scc1 M_B12_1
    s_waitcnt vmcnt(5) lgkmcnt(2)
    v_smfmac_f32_32x32x16_bf16 v[224:239], v[4:5], v[28:31], v10
    buffer_load_dwordx4 v[28:31], v[18:19], s[4:7], 0 idxen offen
    v_perm_b32 v4, v17, v16, v8
    v_perm_b32 v5, v17, v16, v9
    ds_read_b96 v[16:18], v2 offset:320
M_B11_2:
    s_sub_u32 s39, s39, 1
    s_cbranch_scc1 M_B12_2
    s_waitcnt vmcnt(5) lgkmcnt(2)
    v_smfmac_f32_32x32x16_bf16 v[224:239], v[4:5], v[32:35], v10
    buffer_load_dwordx4 v[32:35], v[22:23], s[4:7], 0 idxen offen
    v_perm_b32 v4, v21, v20, v8
    v_perm_b32 v5, v21, v20, v9
    ds_read_b96 v[20:22], v2 offset:352
M_B11_3:
    s_sub_u32 s39, s39, 1
    s_cbranch_scc1 M_B12_3
    s_waitcnt vmcnt(5) lgkmcnt(2)
    v_smfmac_f32_32x32x16_bf16 v[224:239], v[4:5], v[36:39], v10
    buffer_load_dwordx4 v[36:39], v[14:15], s[4:7], 0 idxen offen
    v_perm_b32 v4, v13, v12, v8
    v_perm_b32 v5, v13, v12, v9
    ds_read_b96 v[12:14], v2 offset:384
M_B11_4:
    s_sub_u32 s39, s39, 1
    s_cbranch_scc1 M_B12_4
    s_waitcnt vmcnt(5) lgkmcnt(2)
    v_smfmac_f32_32x32x16_bf16 v[224:239], v[4:5], v[40:43], v10
    buffer_load_dwordx4 v[40:43], v[18:19], s[4:7], 0 idxen offen
    v_perm_b32 v4, v17, v16, v8
    v_perm_b32 v5, v17, v16, v9
    ds_read_b96 v[16:18], v2 offset:416
M_B11_5:
    s_sub_u32 s39, s39, 1
    s_cbranch_scc1 M_B12_5
    s_waitcnt vmcnt(5) lgkmcnt(2)
    v_smfmac_f32_32x32x16_bf16 v[224:239], v[4:5], v[44:47], v10
    buffer_load_dwordx4 v[44:47], v[22:23], s[4:7], 0 idxen offen
    v_perm_b32 v4, v21, v20, v8
    v_perm_b32 v5, v21, v20, v9
    ds_read_b96 v[20:22], v2 offset:448
    v_add_u32 v2, 192, v2
    s_branch M_B11_0
M_B12_0:
    s_sub_u32 s40, s40, 1
    s_cbranch_scc1 M_PE0
    s_waitcnt vmcnt(5) lgkmcnt(2)
    v_smfmac_f32_32x32x16_bf16 v[240:255], v[4:5], v[24:27], v10
    buffer_load_dwordx4 v[24:27], v[14:15], s[4:7], 0 idxen offen
    v_perm_b32 v4, v13, v12, v8
    v_perm_b32 v5, v13, v12, v9
    ds_read_b96 v[12:14], v2 offset:288
M_B12_1:
    s_sub_u32 s40, s40, 1
    s_cbranch_scc1 M_PE1
    s_waitcnt vmcnt(5) lgkmcnt(2)
    v_smfmac_f32_32x32x16_bf16 v[240:255], v[4:5], v[28:31], v10
    buffer_load_dwordx4 v[28:31], v[18:19], s[4:7], 0 idxen offen
    v_perm_b32 v4, v17, v16, v8
    v_perm_b32 v5, v17, v16, v9
    ds_read_b96 v[16:18], v2 offset:320
M_B12_2:
    s_sub_u32 s40, s40, 1
    s_cbranch_scc1 M_PE2
    s_waitcnt vmcnt(5) lgkmcnt(2)
    v_smfmac_f32_32x32x16_bf16 v[240:255], v[4:5], v[32:35], v10
    buffer_load_dwordx4 v[32:35], v[22:23], s[4:7], 0 idxen offen
    v_perm_b32 v4, v21, v20, v8
    v_perm_b32 v5, v21, v20, v9
    ds_read_b96 v[20:22], v2 offset:352
M_B12_3:
    s_sub_u32 s40, s40, 1
    s_cbranch_scc1 M_PE3
    s_waitcnt vmcnt(5) lgkmcnt(2)
    v_smfmac_f32_32x32x16_bf16 v[240:255], v[4:5], v[36:39], v10
    buffer_load_dwordx4 v[36:39], v[14:15], s[4:7], 0 idxen offen
    v_perm_b32 v4, v13, v12, v8
    v_perm_b32 v5, v13, v12, v9
    ds_read_b96 v[12:14], v2 offset:384
M_B12_4:
    s_sub_u32 s40, s40, 1
    s_cbranch_scc1 M_PE4
    s_waitcnt vmcnt(5) lgkmcnt(2)
    v_smfmac_f32_32x32x16_bf16 v[240:255], v[4:5], v[40:43], v10
    buffer_load_dwordx4 v[40:43], v[18:19], s[4:7], 0 idxen offen
    v_perm_b32 v4, v17, v16, v8
    v_perm_b32 v5, v17, v16, v9
    ds_read_b96 v[16:18], v2 offset:416
M_B12_5:
    s_sub_u32 s40, s40, 1
    s_cbranch_scc1 M_PE5
    s_waitcnt vmcnt(5) lgkmcnt(2)
    v_smfmac_f32_32x32x16_bf16 v[240:255], v[4:5], v[44:47], v10
    buffer_load_dwordx4 v[44:47], v[22:23], s[4:7], 0 idxen offen
    v_perm_b32 v4, v21, v20, v8
    v_perm_b32 v5, v21, v20, v9
    ds_read_b96 v[20:22], v2 offset:448
    v_add_u32 v2, 192, v2
    s_branch M_B12_0
M_PE0:
    s_cmp_ge_u32 s23, 64
    s_cbranch_scc1 M_epi
    s_add_u32 s24, s23, 0
    v_readlane_b32 s28, v0, s24
    v_readlane_b32 s29, v1, s24
    s_add_u32 s24, s23, 1
    v_readlane_b32 s30, v0, s24
    v_readlane_b32 s31, v1, s24
    s_add_u32 s24, s23, 2
    v_readlane_b32 s32, v0, s24
    v_readlane_b32 s33, v1, s24
    s_add_u32 s24, s23, 3
    v_readlane_b32 s34, v0, s24
    v_readlane_b32 s35, v1, s24
    s_add_u32 s24, s23, 4
    v_readlane_b32 s36, v0, s24
    v_readlane_b32 s37, v1, s24
    s_add_u32 s24, s23, 5
    v_readlane_b32 s38, v0, s24
    v_readlane_b32 s39, v1, s24
    s_add_u32 s24, s23, 6
    v_readlane_b32 s40, v0, s24
    s_add_u32 s23, s23, 8
    s_branch M_B0_0
M_PE1:
    s_cmp_ge_u32 s23, 64
    s_cbranch_scc1 M_epi
    s_add_u32 s24, s23, 0
    v_readlane_b32 s28, v0, s24
    v_readlane_b32 s29, v1, s24
    s_add_u32 s24, s23, 1
    v_readlane_b32 s30, v0, s24
    v_readlane_b32 s31, v1, s24
    s_add_u32 s24, s23, 2
    v_readlane_b32 s32, v0, s24
    v_readlane_b32 s33, v1, s24
    s_add_u32 s24, s23, 3
    v_readlane_b32 s34, v0, s24
    v_readlane_b32 s35, v1, s24
    s_add_u32 s24, s23, 4
    v_readlane_b32 s36, v0, s24
    v_readlane_b32 s37, v1, s24
    s_add_u32 s24, s23, 5
    v_readlane_b32 s38, v0, s24
    v_readlane_b32 s39, v1, s24
    s_add_u32 s24, s23, 6
    v_readlane_b32 s40, v0, s24
    s_add_u32 s23, s23, 8
    s_branch M_B0_1
M_PE2:
    s_cmp_ge_u32 s23, 64
    s_cbranch_scc1 M_epi
    s_add_u32 s24, s23, 0
    v_readlane_b32 s28, v0, s24
    v_readlane_b32 s29, v1, s24
    s_add_u32 s24, s23, 1
    v_readlane_b32 s30, v0, s24
    v_readlane_b32 s31, v1, s24
    s_add_u32 s24, s23, 2
    v_readlane_b32 s32, v0, s24
    v_readlane_b32 s33, v1, s24
    s_add_u32 s24, s23, 3
    v_readlane_b32 s34, v0, s24
    v_readlane_b32 s35, v1, s24
    s_add_u32 s24, s23, 4
    v_readlane_b32 s36, v0, s24
    v_readlane_b32 s37, v1, s24
    s_add_u32 s24, s23, 5
    v_readlane_b32 s38, v0, s24
    v_readlane_b32 s39, v1, s24
    s_add_u32 s24, s23, 6
    v_readlane_b32 s40, v0, s24
    s_add_u32 s23, s23, 8
    s_branch M_B0_2
M_PE3:
    s_cmp_ge_u32 s23, 64
    s_cbranch_scc1 M_epi
    s_add_u32 s24, s23, 0
    v_readlane_b32 s28, v0, s24
    v_readlane_b32 s29, v1, s24
    s_add_u32 s24, s23, 1
    v_readlane_b32 s30, v0, s24
    v_readlane_b32 s31, v1, s24
    s_add_u32 s24, s23, 2
    v_readlane_b32 s32, v0, s24
    v_readlane_b32 s33, v1, s24
    s_add_u32 s24, s23, 3
    v_readlane_b32 s34, v0, s24
    v_readlane_b32 s35, v1, s24
    s_add_u32 s24, s23, 4
    v_readlane_b32 s36, v0, s24
    v_readlane_b32 s37, v1, s24
    s_add_u32 s24, s23, 5
    v_readlane_b32 s38, v0, s24
    v_readlane_b32 s39, v1, s24
    s_add_u32 s24, s23, 6
    v_readlane_b32 s40, v0, s24
    s_add_u32 s23, s23, 8
    s_branch M_B0_3
M_PE4:
    s_cmp_ge_u32 s23, 64
    s_cbranch_scc1 M_epi
    s_add_u32 s24, s23, 0
    v_readlane_b32 s28, v0, s24
    v_readlane_b32 s29, v1, s24
    s_add_u32 s24, s23, 1
    v_readlane_b32 s30, v0, s24
    v_readlane_b32 s31, v1, s24
    s_add_u32 s24, s23, 2
    v_readlane_b32 s32, v0, s24
    v_readlane_b32 s33, v1, s24
    s_add_u32 s24, s23, 3
    v_readlane_b32 s34, v0, s24
    v_readlane_b32 s35, v1, s24
    s_add_u32 s24, s23, 4
    v_readlane_b32 s36, v0, s24
    v_readlane_b32 s37, v1, s24
    s_add_u32 s24, s23, 5
    v_readlane_b32 s38, v0, s24
    v_readlane_b32 s39, v1, s24
    s_add_u32 s24, s23, 6
    v_readlane_b32 s40, v0, s24
    s_add_u32 s23, s23, 8
    s_branch M_B0_4
M_PE5:
    s_cmp_ge_u32 s23, 64
    s_cbranch_scc1 M_epi
    s_add_u32 s24, s23, 0
    v_readlane_b32 s28, v0, s24
    v_readlane_b32 s29, v1, s24
    s_add_u32 s24, s23, 1
    v_readlane_b32 s30, v0, s24
    v_readlane_b32 s31, v1, s24
    s_add_u32 s24, s23, 2
    v_readlane_b32 s32, v0, s24
    v_readlane_b32 s33, v1, s24
    s_add_u32 s24, s23, 3
    v_readlane_b32 s34, v0, s24
    v_readlane_b32 s35, v1, s24
    s_add_u32 s24, s23, 4
    v_readlane_b32 s36, v0, s24
    v_readlane_b32 s37, v1, s24
    s_add_u32 s24, s23, 5
    v_readlane_b32 s38, v0, s24
    v_readlane_b32 s39, v1, s24
    s_add_u32 s24, s23, 6
    v_readlane_b32 s40, v0, s24
    s_add_u32 s23, s23, 8
    s_branch M_B0_5
M_epi:
    s_setprio 0
    v_lshl_add_u32 v0, v3, 3, s22
    v_and_b32 v4, 15, v3
    v_lshrrev_b32 v5, 4, v3
    v_mul_u32_u24 v1, 528, v4
    v_lshl_add_u32 v1, v5, 4, v1
    v_add_u32 v1, s22, v1
    v_lshlrev_b32 v2, 4, v3
    v_add_u32 v2, 13824, v2
    s_lshl_b32 s24, s18, 6
    v_lshl_add_u32 v4, v4, 2, s24
    ds_read_b32 v4, v4 offset:13312
    s_mov_b32 s26, 0x80008000
    v_cvt_pk_bf16_f32 v48, v48, v49
    v_cvt_pk_bf16_f32 v49, v50, v51
    v_cvt_pk_bf16_f32 v64, v64, v65
    v_cvt_pk_bf16_f32 v65, v66, v67
    v_cvt_pk_bf16_f32 v80, v80, v81
    v_cvt_pk_bf16_f32 v81, v82, v83
    v_cvt_pk_bf16_f32 v96, v96, v97
    v_cvt_pk_bf16_f32 v97, v98, v99
    v_cvt_pk_bf16_f32 v112, v112, v113
    v_cvt_pk_bf16_f32 v113, v114, v115
    v_cvt_pk_bf16_f32 v128, v128, v129
    v_cvt_pk_bf16_f32 v129, v130, v131
    v_cvt_pk_bf16_f32 v144, v144, v145
    v_cvt_pk_bf16_f32 v145, v146, v147
    v_cvt_pk_bf16_f32 v160, v160, v161
    v_cvt_pk_bf16_f32 v161, v162, v163
    v_cvt_pk_bf16_f32 v176, v176, v177
    v_cvt_pk_bf16_f32 v177, v178, v179
    v_cvt_pk_bf16_f32 v192, v192, v193
    v_cvt_pk_bf16_f32 v193, v194, v195
    v_cvt_pk_bf16_f32 v208, v208, v209
    v_cvt_pk_bf16_f32 v209, v210, v211
    v_cvt_pk_bf16_f32 v224, v224, v225
    v_cvt_pk_bf16_f32 v225, v226, v227
    v_cvt_pk_bf16_f32 v240, v240, v241
    v_cvt_pk_bf16_f32 v241, v242, v243
    s_waitcnt vmcnt(0) lgkmcnt(0)
    ds_write_b64 v0, v[48:49] offset:0
    ds_write_b64 v0, v[64:65] offset:528
    ds_write_b64 v0, v[80:81] offset:1056
    ds_write_b64 v0, v[96:97] offset:1584
    ds_write_b64 v0, v[112:113] offset:2112
    ds_write_b64 v0, v[128:129] offset:2640
    ds_write_b64 v0, v[144:145] offset:3168
    ds_write_b64 v0, v[160:161] offset:3696
    ds_write_b64 v0, v[176:177] offset:4224
    ds_write_b64 v0, v[192:193] offset:4752
    ds_write_b64 v0, v[208:209] offset:5280
    ds_write_b64 v0, v[224:225] offset:5808
    ds_write_b64 v0, v[240:241] offset:6336
    ds_read_b128 v[8:11], v1 offset:0
    ds_read_b128 v[12:15], v1 offset:256
    ds_read_b128 v[16:19], v1 offset:64
    ds_read_b128 v[20:23], v1 offset:320
    ds_read_b128 v[24:27], v1 offset:128
    ds_read_b128 v[28:31], v1 offset:384
    ds_read_b128 v[32:35], v1 offset:192
    ds_read_b128 v[36:39], v1 offset:448
    ds_read_b128 v[176:179], v2 offset:0
    ds_read_b128 v[192:195], v2 offset:4096
    ds_read_b128 v[208:211], v2 offset:1024
    ds_read_b128 v[224:227], v2 offset:5120
    ds_read_b128 v[240:243], v2 offset:2048
    ds_read_b128 v[40:43], v2 offset:6144
    ds_read_b128 v[44:47], v2 offset:3072
    v_cvt_pk_bf16_f32 v52, v52, v53
    v_cvt_pk_bf16_f32 v53, v54, v55
    v_cvt_pk_bf16_f32 v68, v68, v69
    v_cvt_pk_bf16_f32 v69, v70, v71
    v_cvt_pk_bf16_f32 v84, v84, v85
    v_cvt_pk_bf16_f32 v85, v86, v87
    v_cvt_pk_bf16_f32 v100, v100, v101
    v_cvt_pk_bf16_f32 v101, v102, v103
    v_cvt_pk_bf16_f32 v116, v116, v117
    v_cvt_pk_bf16_f32 v117, v118, v119
    v_cvt_pk_bf16_f32 v132, v132, v133
    v_cvt_pk_bf16_f32 v133, v134, v135
    v_cvt_pk_bf16_f32 v148, v148, v149
    v_cvt_pk_bf16_f32 v149, v150, v151
    v_cvt_pk_bf16_f32 v164, v164, v165
    v_cvt_pk_bf16_f32 v165, v166, v167
    v_cvt_pk_bf16_f32 v180, v180, v181
    v_cvt_pk_bf16_f32 v181, v182, v183
    v_cvt_pk_bf16_f32 v196, v196, v197
    v_cvt_pk_bf16_f32 v197, v198, v199
    v_cvt_pk_bf16_f32 v212, v212, v213
    v_cvt_pk_bf16_f32 v213, v214, v215
    v_cvt_pk_bf16_f32 v228, v228, v229
    v_cvt_pk_bf16_f32 v229, v230, v231
    v_cvt_pk_bf16_f32 v244, v244, v245
    v_cvt_pk_bf16_f32 v245, v246, v247
    ds_write_b64 v0, v[52:53] offset:0
    ds_write_b64 v0, v[68:69] offset:528
    ds_write_b64 v0, v[84:85] offset:1056
    ds_write_b64 v0, v[100:101] offset:1584
    ds_write_b64 v0, v[116:117] offset:2112
    ds_write_b64 v0, v[132:133] offset:2640
    ds_write_b64 v0, v[148:149] offset:3168
    ds_write_b64 v0, v[164:165] offset:3696
    ds_write_b64 v0, v[180:181] offset:4224
    ds_write_b64 v0, v[196:197] offset:4752
    ds_write_b64 v0, v[212:213] offset:5280
    ds_write_b64 v0, v[228:229] offset:5808
    ds_write_b64 v0, v[244:245] offset:6336
    s_or_b32 s27, s19, s21
    s_cmp_eq_u32 s27, 0
    s_cbranch_scc0 M_multi
    s_waitcnt lgkmcnt(15)
    v_mfma_f32_16x16x32_bf16 v[52:55], v[176:179], v[8:11], 0
    ds_read_b128 v[48:51], v1 offset:0
    ds_read_b128 v[64:67], v1 offset:256
    ds_read_b128 v[80:83], v1 offset:64
    ds_read_b128 v[176:179], v2 offset:7168
    v_mfma_f32_16x16x32_bf16 v[52:55], v[192:195], v[12:15], v[52:55]
    ds_read_b128 v[96:99], v1 offset:320
    ds_read_b128 v[112:115], v1 offset:128
    ds_read_b128 v[128:131], v1 offset:384
    ds_read_b128 v[192:195], v2 offset:24576
    v_mfma_f32_16x16x32_bf16 v[68:71], v[208:211], v[8:11], 0
    ds_read_b128 v[144:147], v1 offset:192
    ds_read_b128 v[160:163], v1 offset:448
    v_cvt_pk_bf16_f32 v56, v56, v57
    ds_read_b128 v[208:211], v2 offset:28672
    v_mfma_f32_16x16x32_bf16 v[68:71], v[224:227], v[12:15], v[68:71]
    v_cvt_pk_bf16_f32 v57, v58, v59
    v_cvt_pk_bf16_f32 v72, v72, v73
    v_cvt_pk_bf16_f32 v73, v74, v75
    ds_read_b128 v[224:227], v2 offset:25600
    v_mfma_f32_16x16x32_bf16 v[84:87], v[240:243], v[8:11], 0
    v_cvt_pk_bf16_f32 v88, v88, v89
    v_cvt_pk_bf16_f32 v89, v90, v91
    v_cvt_pk_bf16_f32 v104, v104, v105
    ds_read_b128 v[240:243], v2 offset:29696
    s_waitcnt lgkmcnt(15)
    v_mfma_f32_16x16x32_bf16 v[84:87], v[40:43], v[12:15], v[84:87]
    v_cvt_pk_bf16_f32 v105, v106, v107
    v_cvt_pk_bf16_f32 v120, v120, v121
    v_cvt_pk_bf16_f32 v121, v122, v123
    ds_read_b128 v[40:43], v2 offset:26624
    v_mfma_f32_16x16x32_bf16 v[100:103], v[44:47], v[8:11], 0
    v_cvt_pk_bf16_f32 v136, v136, v137
    v_cvt_pk_bf16_f32 v137, v138, v139
    v_cvt_pk_bf16_f32 v152, v152, v153
    ds_read_b128 v[44:47], v2 offset:30720
    s_waitcnt lgkmcnt(11)
    v_mfma_f32_16x16x32_bf16 v[100:103], v[176:179], v[12:15], v[100:103]
    v_cvt_pk_bf16_f32 v153, v154, v155
    v_cvt_pk_bf16_f32 v168, v168, v169
    v_cvt_pk_bf16_f32 v169, v170, v171
    ds_read_b128 v[176:179], v2 offset:27648
    s_waitcnt lgkmcnt(8)
    v_mfma_f32_16x16x32_bf16 v[116:119], v[192:195], v[16:19], 0
    v_cvt_pk_bf16_f32 v184, v184, v185
    v_cvt_pk_bf16_f32 v185, v186, v187
    v_cvt_pk_bf16_f32 v200, v200, v201
    v_mfma_f32_16x16x32_bf16 v[132:135], v[192:195], v[24:27], 0
    v_cvt_pk_bf16_f32 v201, v202, v203
    v_cvt_pk_bf16_f32 v216, v216, v217
    v_cvt_pk_bf16_f32 v217, v218, v219
    v_mfma_f32_16x16x32_bf16 v[148:151], v[192:195], v[32:35], 0
    v_cvt_pk_bf16_f32 v232, v232, v233
    v_cvt_pk_bf16_f32 v233, v234, v235
    v_cvt_pk_bf16_f32 v248, v248, v249
    ds_read_b128 v[192:195], v2 offset:31744
    s_waitcnt lgkmcnt(6)
    v_mfma_f32_16x16x32_bf16 v[116:119], v[208:211], v[20:23], v[116:119]
    v_cvt_pk_bf16_f32 v249, v250, v251
    ds_write_b64 v0, v[56:57] offset:0
    ds_write_b64 v0, v[72:73] offset:528
    v_mfma_f32_16x16x32_bf16 v[132:135], v[208:211], v[28:31], v[132:135]
    ds_write_b64 v0, v[88:89] offset:1056
    ds_write_b64 v0, v[104:105] offset:1584
    ds_write_b64 v0, v[120:121] offset:2112
    v_mfma_f32_16x16x32_bf16 v[148:151], v[208:211], v[36:39], v[148:151]
    ds_write_b64 v0, v[136:137] offset:2640
    ds_write_b64 v0, v[152:153] offset:3168
    ds_write_b64 v0, v[168:169] offset:3696
    ds_read_b128 v[208:211], v2 offset:8192
    s_waitcnt lgkmcnt(14)
    v_mfma_f32_16x16x32_bf16 v[164:167], v[224:227], v[16:19], 0
    ds_write_b64 v0, v[184:185] offset:4224
    ds_write_b64 v0, v[200:201] offset:4752
    ds_write_b64 v0, v[216:217] offset:5280
    v_mfma_f32_16x16x32_bf16 v[180:183], v[224:227], v[24:27], 0
    ds_write_b64 v0, v[232:233] offset:5808
    ds_write_b64 v0, v[248:249] offset:6336
    ds_read_b128 v[104:107], v1 offset:0
    v_mfma_f32_16x16x32_bf16 v[196:199], v[224:227], v[32:35], 0
    ds_read_b128 v[120:123], v1 offset:256
    ds_read_b128 v[136:139], v1 offset:64
    ds_read_b128 v[152:155], v1 offset:320
    ds_read_b128 v[224:227], v2 offset:12288
    s_waitcnt lgkmcnt(15)
    v_mfma_f32_16x16x32_bf16 v[164:167], v[240:243], v[20:23], v[164:167]
    ds_read_b128 v[168:171], v1 offset:128
    ds_read_b128 v[184:187], v1 offset:384
    ds_read_b128 v[200:203], v1 offset:192
    v_mfma_f32_16x16x32_bf16 v[180:183], v[240:243], v[28:31], v[180:183]
    ds_read_b128 v[216:219], v1 offset:448
    v_cvt_pk_bf16_f32 v60, v60, v61
    v_cvt_pk_bf16_f32 v61, v62, v63
    v_mfma_f32_16x16x32_bf16 v[196:199], v[240:243], v[36:39], v[196:199]
    v_cvt_pk_bf16_f32 v76, v76, v77
    v_cvt_pk_bf16_f32 v77, v78, v79
    v_cvt_pk_bf16_f32 v92, v92, v93
    ds_read_b128 v[240:243], v2 offset:9216
    v_mfma_f32_16x16x32_bf16 v[212:215], v[40:43], v[16:19], 0
    v_cvt_pk_bf16_f32 v93, v94, v95
    v_cvt_pk_bf16_f32 v108, v108, v109
    v_cvt_pk_bf16_f32 v109, v110, v111
    v_mfma_f32_16x16x32_bf16 v[228:231], v[40:43], v[24:27], 0
    v_cvt_pk_bf16_f32 v124, v124, v125
    v_cvt_pk_bf16_f32 v125, v126, v127
    v_cvt_pk_bf16_f32 v140, v140, v141
    v_mfma_f32_16x16x32_bf16 v[244:247], v[40:43], v[32:35], 0
    v_cvt_pk_bf16_f32 v141, v142, v143
    v_cvt_pk_bf16_f32 v156, v156, v157
    v_cvt_pk_bf16_f32 v157, v158, v159
    ds_read_b128 v[40:43], v2 offset:13312
    v_mfma_f32_16x16x32_bf16 v[212:215], v[44:47], v[20:23], v[212:215]
    v_cvt_pk_bf16_f32 v172, v172, v173
    v_cvt_pk_bf16_f32 v173, v174, v175
    v_cvt_pk_bf16_f32 v188, v188, v189
    v_mfma_f32_16x16x32_bf16 v[228:231], v[44:47], v[28:31], v[228:231]
    v_cvt_pk_bf16_f32 v189, v190, v191
    v_cvt_pk_bf16_f32 v204, v204, v205
    v_cvt_pk_bf16_f32 v205, v206, v207
    v_mfma_f32_16x16x32_bf16 v[244:247], v[44:47], v[36:39], v[244:247]
    v_cvt_pk_bf16_f32 v220, v220, v221
    v_cvt_pk_bf16_f32 v221, v222, v223
    v_cvt_pk_bf16_f32 v236, v236, v237
    ds_read_b128 v[44:47], v2 offset:10240
    v_mfma_f32_16x16x32_bf16 v[56:59], v[176:179], v[16:19], 0
    v_cvt_pk_bf16_f32 v237, v238, v239
    v_cvt_pk_bf16_f32 v252, v252, v253
    v_cvt_pk_bf16_f32 v253, v254, v255
    v_mfma_f32_16x16x32_bf16 v[72:75], v[176:179], v[24:27], 0
    ds_write_b64 v0, v[60:61] offset:0
    ds_write_b64 v0, v[76:77] offset:528
    ds_write_b64 v0, v[92:93] offset:1056
    v_mfma_f32_16x16x32_bf16 v[88:91], v[176:179], v[32:35], 0
    ds_write_b64 v0, v[108:109] offset:1584
    ds_write_b64 v0, v[124:125] offset:2112
    ds_write_b64 v0, v[140:141] offset:2640
    ds_read_b128 v[176:179], v2 offset:14336
    v_mfma_f32_16x16x32_bf16 v[56:59], v[192:195], v[20:23], v[56:59]
    ds_write_b64 v0, v[156:157] offset:3168
    ds_write_b64 v0, v[172:173] offset:3696
    ds_write_b64 v0, v[188:189] offset:4224
    v_mfma_f32_16x16x32_bf16 v[72:75], v[192:195], v[28:31], v[72:75]
    ds_write_b64 v0, v[204:205] offset:4752
    ds_write_b64 v0, v[220:221] offset:5280
    ds_write_b64 v0, v[236:237] offset:5808
    v_mfma_f32_16x16x32_bf16 v[88:91], v[192:195], v[36:39], v[88:91]
    ds_write_b64 v0, v[252:253] offset:6336
    ds_read_b128 v[60:63], v1 offset:0
    ds_read_b128 v[76:79], v1 offset:256
    ds_read_b128 v[192:195], v2 offset:11264
    ds_read_b128 v[92:95], v1 offset:64
    ds_read_b128 v[108:111], v1 offset:320
    ds_read_b128 v[124:127], v1 offset:128
    ds_read_b128 v[140:143], v1 offset:384
    ds_read_b128 v[156:159], v1 offset:192
    ds_read_b128 v[172:175], v1 offset:448
    s_waitcnt lgkmcnt(15)
    v_mfma_f32_16x16x32_bf16 v[52:55], v[208:211], v[80:83], v[52:55]
    v_cmp_gt_u32 vcc, 98, v4
    s_mul_i32 s24, s2, 98
    v_add_u32 v4, s24, v4
    v_mfma_f32_16x16x32_bf16 v[52:55], v[208:211], v[168:171], v[52:55]
    v_lshlrev_b32 v4, 9, v4
    v_lshl_add_u32 v4, v5, 4, v4
    v_mov_b32 v5, 0x7ffff000
    s_waitcnt lgkmcnt(1)
    v_mfma_f32_16x16x32_bf16 v[52:55], v[208:211], v[156:159], v[52:55]
    v_cndmask_b32 v4, v5, v4, vcc
    s_mov_b32 s24, 0xbfb8aa3b
    v_xor_b32 v144, s26, v144
    ds_read_b128 v[208:211], v2 offset:15360
    v_mfma_f32_16x16x32_bf16 v[52:55], v[224:227], v[96:99], v[52:55]
    v_xor_b32 v145, s26, v145
    v_xor_b32 v146, s26, v146
    v_xor_b32 v147, s26, v147
    v_mfma_f32_16x16x32_bf16 v[52:55], v[224:227], v[184:187], v[52:55]
    v_xor_b32 v160, s26, v160
    v_xor_b32 v161, s26, v161
    v_xor_b32 v162, s26, v162
    s_waitcnt lgkmcnt(1)
    v_mfma_f32_16x16x32_bf16 v[52:55], v[224:227], v[172:175], v[52:55]
    v_xor_b32 v163, s26, v163
    v_xor_b32 v136, s26, v136
    v_xor_b32 v137, s26, v137
    ds_read_b128 v[224:227], v2 offset:16384
    v_mfma_f32_16x16x32_bf16 v[68:71], v[240:243], v[80:83], v[68:71]
    v_xor_b32 v138, s26, v138
    v_xor_b32 v139, s26, v139
    v_xor_b32 v152, s26, v152
    v_mfma_f32_16x16x32_bf16 v[68:71], v[240:243], v[168:171], v[68:71]
    v_xor_b32 v153, s26, v153
    v_xor_b32 v154, s26, v154
    v_xor_b32 v155, s26, v155
    v_mfma_f32_16x16x32_bf16 v[68:71], v[240:243], v[156:159], v[68:71]
    v_xor_b32 v124, s26, v124
    v_xor_b32 v125, s26, v125
    v_xor_b32 v126, s26, v126
    ds_read_b128 v[240:243], v2 offset:20480
    v_mfma_f32_16x16x32_bf16 v[68:71], v[40:43], v[96:99], v[68:71]
    v_xor_b32 v127, s26, v127
    v_xor_b32 v140, s26, v140
    v_xor_b32 v141, s26, v141
    v_mfma_f32_16x16x32_bf16 v[68:71], v[40:43], v[184:187], v[68:71]
    v_xor_b32 v142, s26, v142
    v_xor_b32 v143, s26, v143
    v_mfma_f32_16x16x32_bf16 v[68:71], v[40:43], v[172:175], v[68:71]
    ds_read_b128 v[40:43], v2 offset:32768
    v_mfma_f32_16x16x32_bf16 v[84:87], v[44:47], v[80:83], v[84:87]
    v_mfma_f32_16x16x32_bf16 v[84:87], v[44:47], v[168:171], v[84:87]
    v_mfma_f32_16x16x32_bf16 v[84:87], v[44:47], v[156:159], v[84:87]
    ds_read_b128 v[44:47], v2 offset:36864
    v_mfma_f32_16x16x32_bf16 v[84:87], v[176:179], v[96:99], v[84:87]
    v_mfma_f32_16x16x32_bf16 v[84:87], v[176:179], v[184:187], v[84:87]
    v_mfma_f32_16x16x32_bf16 v[84:87], v[176:179], v[172:175], v[84:87]
    ds_read_b128 v[176:179], v2 offset:17408
    v_mfma_f32_16x16x32_bf16 v[100:103], v[192:195], v[80:83], v[100:103]
    v_mfma_f32_16x16x32_bf16 v[100:103], v[192:195], v[168:171], v[100:103]
    v_mfma_f32_16x16x32_bf16 v[100:103], v[192:195], v[156:159], v[100:103]
    ds_read_b128 v[192:195], v2 offset:21504
    s_waitcnt lgkmcnt(6)
    v_mfma_f32_16x16x32_bf16 v[100:103], v[208:211], v[96:99], v[100:103]
    v_mfma_f32_16x16x32_bf16 v[100:103], v[208:211], v[184:187], v[100:103]
    v_mfma_f32_16x16x32_bf16 v[100:103], v[208:211], v[172:175], v[100:103]
    ds_read_b128 v[208:211], v2 offset:33792
    s_waitcnt lgkmcnt(6)
    v_mfma_f32_16x16x32_bf16 v[116:119], v[224:227], v[48:51], v[116:119]
    v_mfma_f32_16x16x32_bf16 v[132:135], v[224:227], v[104:107], v[132:135]
    v_mfma_f32_16x16x32_bf16 v[148:151], v[224:227], v[60:63], v[148:151]
    ds_read_b128 v[224:227], v2 offset:37888
    s_waitcnt lgkmcnt(6)
    v_mfma_f32_16x16x32_bf16 v[116:119], v[240:243], v[64:67], v[116:119]
    v_mul_f32 v188, s24, v52
    v_mul_f32 v189, s24, v53
    v_mul_f32 v190, s24, v54
    v_mfma_f32_16x16x32_bf16 v[132:135], v[240:243], v[120:123], v[132:135]
    v_mul_f32 v191, s24, v55
    v_mul_f32 v204, s24, v68
    v_mul_f32 v205, s24, v69
    v_mfma_f32_16x16x32_bf16 v[148:151], v[240:243], v[76:79], v[148:151]
    v_mul_f32 v206, s24, v70
    v_mul_f32 v207, s24, v71
    v_mul_f32 v220, s24, v84
    ds_read_b128 v[240:243], v2 offset:18432
    s_waitcnt lgkmcnt(6)
    v_mfma_f32_16x16x32_bf16 v[148:151], v[40:43], v[112:115], v[148:151]
    v_mul_f32 v221, s24, v85
    v_mul_f32 v222, s24, v86
    v_mul_f32 v223, s24, v87
    v_mfma_f32_16x16x32_bf16 v[132:135], v[40:43], v[144:147], v[132:135]
    v_mul_f32 v236, s24, v100
    v_mul_f32 v237, s24, v101
    v_mul_f32 v238, s24, v102
    v_mfma_f32_16x16x32_bf16 v[148:151], v[40:43], v[136:139], v[148:151]
    v_mul_f32 v239, s24, v103
    v_exp_f32 v188, v188
    v_exp_f32 v189, v189
    v_mfma_f32_16x16x32_bf16 v[116:119], v[40:43], v[200:203], v[116:119]
    v_exp_f32 v190, v190
    v_exp_f32 v191, v191
    v_exp_f32 v204, v204
    v_mfma_f32_16x16x32_bf16 v[132:135], v[40:43], v[92:95], v[132:135]
    v_exp_f32 v205, v205
    v_exp_f32 v206, v206
    v_exp_f32 v207, v207
    v_mfma_f32_16x16x32_bf16 v[116:119], v[40:43], v[124:127], v[116:119]
    v_exp_f32 v220, v220
    v_exp_f32 v221, v221
    v_exp_f32 v222, v222
    ds_read_b128 v[40:43], v2 offset:22528
    s_waitcnt lgkmcnt(6)
    v_mfma_f32_16x16x32_bf16 v[148:151], v[44:47], v[128:131], v[148:151]
    v_exp_f32 v223, v223
    v_exp_f32 v236, v236
    v_exp_f32 v237, v237
    v_mfma_f32_16x16x32_bf16 v[132:135], v[44:47], v[160:163], v[132:135]
    v_exp_f32 v238, v238
    v_exp_f32 v239, v239
    v_add_f32 v188, 1.0, v188
    v_mfma_f32_16x16x32_bf16 v[148:151], v[44:47], v[152:155], v[148:151]
    v_add_f32 v189, 1.0, v189
    v_add_f32 v190, 1.0, v190
    v_add_f32 v191, 1.0, v191
    v_mfma_f32_16x16x32_bf16 v[116:119], v[44:47], v[216:219], v[116:119]
    v_add_f32 v204, 1.0, v204
    v_add_f32 v205, 1.0, v205
    v_add_f32 v206, 1.0, v206
    v_mfma_f32_16x16x32_bf16 v[132:135], v[44:47], v[108:111], v[132:135]
    v_add_f32 v207, 1.0, v207
    v_add_f32 v220, 1.0, v220
    v_add_f32 v221, 1.0, v221
    v_mfma_f32_16x16x32_bf16 v[116:119], v[44:47], v[140:143], v[116:119]
    v_add_f32 v222, 1.0, v222
    v_add_f32 v223, 1.0, v223
    v_add_f32 v236, 1.0, v236
    ds_read_b128 v[44:47], v2 offset:34816
    s_waitcnt lgkmcnt(6)
    v_mfma_f32_16x16x32_bf16 v[164:167], v[176:179], v[48:51], v[164:167]
    v_add_f32 v237, 1.0, v237
    v_add_f32 v238, 1.0, v238
    v_add_f32 v239, 1.0, v239
    v_mfma_f32_16x16x32_bf16 v[180:183], v[176:179], v[104:107], v[180:183]
    v_rcp_f32 v188, v188
    v_rcp_f32 v189, v189
    v_rcp_f32 v190, v190
    v_mfma_f32_16x16x32_bf16 v[196:199], v[176:179], v[60:63], v[196:199]
    v_rcp_f32 v191, v191
    v_rcp_f32 v204, v204
    v_rcp_f32 v205, v205
    ds_read_b128 v[176:179], v2 offset:38912
    s_waitcnt lgkmcnt(6)
    v_mfma_f32_16x16x32_bf16 v[164:167], v[192:195], v[64:67], v[164:167]
    v_rcp_f32 v206, v206
    v_rcp_f32 v207, v207
    v_rcp_f32 v220, v220
    v_mfma_f32_16x16x32_bf16 v[180:183], v[192:195], v[120:123], v[180:183]
    v_rcp_f32 v221, v221
    v_rcp_f32 v222, v222
    v_rcp_f32 v223, v223
    v_mfma_f32_16x16x32_bf16 v[196:199], v[192:195], v[76:79], v[196:199]
    v_rcp_f32 v236, v236
    v_rcp_f32 v237, v237
    v_rcp_f32 v238, v238
    ds_read_b128 v[192:195], v2 offset:19456
    s_waitcnt lgkmcnt(6)
    v_mfma_f32_16x16x32_bf16 v[196:199], v[208:211], v[112:115], v[196:199]
    v_rcp_f32 v239, v239
    v_cvt_pk_bf16_f32 v8, v52, v53
    v_cvt_pk_bf16_f32 v9, v54, v55
    v_mfma_f32_16x16x32_bf16 v[180:183], v[208:211], v[144:147], v[180:183]
    v_cvt_pk_bf16_f32 v10, v68, v69
    v_cvt_pk_bf16_f32 v11, v70, v71
    buffer_store_dwordx4 v[8:11], v4, s[12:15], 0 offen offset:0 nt
    v_mfma_f32_16x16x32_bf16 v[196:199], v[208:211], v[136:139], v[196:199]
    v_cvt_pk_bf16_f32 v12, v84, v85
    v_cvt_pk_bf16_f32 v13, v86, v87
    v_cvt_pk_bf16_f32 v14, v100, v101
    v_mfma_f32_16x16x32_bf16 v[164:167], v[208:211], v[200:203], v[164:167]
    v_cvt_pk_bf16_f32 v15, v102, v103
    buffer_store_dwordx4 v[12:15], v4, s[12:15], 0 offen offset:64 nt
    v_mfma_f32_16x16x32_bf16 v[180:183], v[208:211], v[92:95], v[180:183]
    v_mfma_f32_16x16x32_bf16 v[164:167], v[208:211], v[124:127], v[164:167]
    ds_read_b128 v[208:211], v2 offset:23552
    s_waitcnt lgkmcnt(6)
    v_mfma_f32_16x16x32_bf16 v[196:199], v[224:227], v[128:131], v[196:199]
    v_mfma_f32_16x16x32_bf16 v[180:183], v[224:227], v[160:163], v[180:183]
    v_mfma_f32_16x16x32_bf16 v[196:199], v[224:227], v[152:155], v[196:199]
    v_mfma_f32_16x16x32_bf16 v[164:167], v[224:227], v[216:219], v[164:167]
    v_mfma_f32_16x16x32_bf16 v[180:183], v[224:227], v[108:111], v[180:183]
    v_mfma_f32_16x16x32_bf16 v[164:167], v[224:227], v[140:143], v[164:167]
    ds_read_b128 v[224:227], v2 offset:35840
    s_waitcnt lgkmcnt(6)
    v_mfma_f32_16x16x32_bf16 v[212:215], v[240:243], v[48:51], v[212:215]
    v_mfma_f32_16x16x32_bf16 v[228:231], v[240:243], v[104:107], v[228:231]
    v_mfma_f32_16x16x32_bf16 v[244:247], v[240:243], v[60:63], v[244:247]
    ds_read_b128 v[240:243], v2 offset:39936
    s_waitcnt lgkmcnt(6)
    v_mfma_f32_16x16x32_bf16 v[212:215], v[40:43], v[64:67], v[212:215]
    v_pk_mul_f32 v[116:117], v[116:117], v[188:189]
    v_pk_mul_f32 v[118:119], v[118:119], v[190:191]
    v_pk_mul_f32 v[164:165], v[164:165], v[204:205]
    v_mfma_f32_16x16x32_bf16 v[228:231], v[40:43], v[120:123], v[228:231]
    v_pk_mul_f32 v[166:167], v[166:167], v[206:207]
    v_cvt_pk_bf16_f32 v16, v116, v117
    v_cvt_pk_bf16_f32 v17, v118, v119
    v_mfma_f32_16x16x32_bf16 v[244:247], v[40:43], v[76:79], v[244:247]
    v_cvt_pk_bf16_f32 v18, v164, v165
    v_cvt_pk_bf16_f32 v19, v166, v167
    buffer_store_dwordx4 v[16:19], v4, s[12:15], 0 offen offset:128 nt
    s_waitcnt lgkmcnt(5)
    v_mfma_f32_16x16x32_bf16 v[244:247], v[44:47], v[112:115], v[244:247]
    v_pk_mul_f32 v[132:133], v[132:133], v[188:189]
    v_pk_mul_f32 v[134:135], v[134:135], v[190:191]
    v_pk_mul_f32 v[180:181], v[180:181], v[204:205]
    v_mfma_f32_16x16x32_bf16 v[228:231], v[44:47], v[144:147], v[228:231]
    v_pk_mul_f32 v[182:183], v[182:183], v[206:207]
    v_cvt_pk_bf16_f32 v24, v132, v133
    v_cvt_pk_bf16_f32 v25, v134, v135
    v_mfma_f32_16x16x32_bf16 v[244:247], v[44:47], v[136:139], v[244:247]
    v_cvt_pk_bf16_f32 v26, v180, v181
    v_cvt_pk_bf16_f32 v27, v182, v183
    buffer_store_dwordx4 v[24:27], v4, s[12:15], 0 offen offset:256 nt
    v_mfma_f32_16x16x32_bf16 v[212:215], v[44:47], v[200:203], v[212:215]
    v_pk_mul_f32 v[148:149], v[148:149], v[188:189]
    v_pk_mul_f32 v[150:151], v[150:151], v[190:191]
    v_pk_mul_f32 v[196:197], v[196:197], v[204:205]
    v_mfma_f32_16x16x32_bf16 v[228:231], v[44:47], v[92:95], v[228:231]
    v_pk_mul_f32 v[198:199], v[198:199], v[206:207]
    v_cvt_pk_bf16_f32 v32, v148, v149
    v_cvt_pk_bf16_f32 v33, v150, v151
    v_mfma_f32_16x16x32_bf16 v[212:215], v[44:47], v[124:127], v[212:215]
    v_cvt_pk_bf16_f32 v34, v196, v197
    v_cvt_pk_bf16_f32 v35, v198, v199
    buffer_store_dwordx4 v[32:35], v4, s[12:15], 0 offen offset:384 nt
    s_waitcnt lgkmcnt(4)
    v_mfma_f32_16x16x32_bf16 v[244:247], v[176:179], v[128:131], v[244:247]
    v_mfma_f32_16x16x32_bf16 v[228:231], v[176:179], v[160:163], v[228:231]
    v_mfma_f32_16x16x32_bf16 v[244:247], v[176:179], v[152:155], v[244:247]
    v_mfma_f32_16x16x32_bf16 v[212:215], v[176:179], v[216:219], v[212:215]
    v_mfma_f32_16x16x32_bf16 v[228:231], v[176:179], v[108:111], v[228:231]
    v_mfma_f32_16x16x32_bf16 v[212:215], v[176:179], v[140:143], v[212:215]
    s_waitcnt lgkmcnt(3)
    v_mfma_f32_16x16x32_bf16 v[56:59], v[192:195], v[48:51], v[56:59]
    v_mfma_f32_16x16x32_bf16 v[72:75], v[192:195], v[104:107], v[72:75]
    v_mfma_f32_16x16x32_bf16 v[88:91], v[192:195], v[60:63], v[88:91]
    s_waitcnt lgkmcnt(2)
    v_mfma_f32_16x16x32_bf16 v[56:59], v[208:211], v[64:67], v[56:59]
    v_mfma_f32_16x16x32_bf16 v[72:75], v[208:211], v[120:123], v[72:75]
    v_mfma_f32_16x16x32_bf16 v[88:91], v[208:211], v[76:79], v[88:91]
    s_waitcnt lgkmcnt(1)
    v_mfma_f32_16x16x32_bf16 v[88:91], v[224:227], v[112:115], v[88:91]
    v_mfma_f32_16x16x32_bf16 v[72:75], v[224:227], v[144:147], v[72:75]
    v_mfma_f32_16x16x32_bf16 v[88:91], v[224:227], v[136:139], v[88:91]
    v_mfma_f32_16x16x32_bf16 v[56:59], v[224:227], v[200:203], v[56:59]
    v_mfma_f32_16x16x32_bf16 v[72:75], v[224:227], v[92:95], v[72:75]
    v_mfma_f32_16x16x32_bf16 v[56:59], v[224:227], v[124:127], v[56:59]
    s_waitcnt lgkmcnt(0)
    v_mfma_f32_16x16x32_bf16 v[88:91], v[240:243], v[128:131], v[88:91]
    v_mfma_f32_16x16x32_bf16 v[72:75], v[240:243], v[160:163], v[72:75]
    v_mfma_f32_16x16x32_bf16 v[88:91], v[240:243], v[152:155], v[88:91]
    v_mfma_f32_16x16x32_bf16 v[56:59], v[240:243], v[216:219], v[56:59]
    v_mfma_f32_16x16x32_bf16 v[72:75], v[240:243], v[108:111], v[72:75]
    v_mfma_f32_16x16x32_bf16 v[56:59], v[240:243], v[140:143], v[56:59]
    v_pk_mul_f32 v[212:213], v[212:213], v[220:221]
    v_pk_mul_f32 v[214:215], v[214:215], v[222:223]
    s_nop 5
    v_pk_mul_f32 v[56:57], v[56:57], v[236:237]
    v_pk_mul_f32 v[58:59], v[58:59], v[238:239]
    v_cvt_pk_bf16_f32 v20, v212, v213
    v_cvt_pk_bf16_f32 v21, v214, v215
    v_cvt_pk_bf16_f32 v22, v56, v57
    v_cvt_pk_bf16_f32 v23, v58, v59
    buffer_store_dwordx4 v[20:23], v4, s[12:15], 0 offen offset:192 nt
    v_pk_mul_f32 v[228:229], v[228:229], v[220:221]
    v_pk_mul_f32 v[230:231], v[230:231], v[222:223]
    v_pk_mul_f32 v[72:73], v[72:73], v[236:237]
    v_pk_mul_f32 v[74:75], v[74:75], v[238:239]
    v_cvt_pk_bf16_f32 v28, v228, v229
    v_cvt_pk_bf16_f32 v29, v230, v231
    v_cvt_pk_bf16_f32 v30, v72, v73
    v_cvt_pk_bf16_f32 v31, v74, v75
    buffer_store_dwordx4 v[28:31], v4, s[12:15], 0 offen offset:320 nt
    v_pk_mul_f32 v[244:245], v[244:245], v[220:221]
    v_pk_mul_f32 v[246:247], v[246:247], v[222:223]
    v_pk_mul_f32 v[88:89], v[88:89], v[236:237]
    v_pk_mul_f32 v[90:91], v[90:91], v[238:239]
    v_cvt_pk_bf16_f32 v36, v244, v245
    v_cvt_pk_bf16_f32 v37, v246, v247
    v_cvt_pk_bf16_f32 v38, v88, v89
    v_cvt_pk_bf16_f32 v39, v90, v91
    buffer_store_dwordx4 v[36:39], v4, s[12:15], 0 offen offset:448 nt
    s_branch M_end
M_multi:
    s_waitcnt lgkmcnt(15)
    v_mfma_f32_16x16x32_bf16 v[52:55], v[176:179], v[8:11], 0
    ds_read_b128 v[48:51], v1 offset:0
    ds_read_b128 v[64:67], v1 offset:256
    ds_read_b128 v[80:83], v1 offset:64
    ds_read_b128 v[176:179], v2 offset:7168
    v_mfma_f32_16x16x32_bf16 v[52:55], v[192:195], v[12:15], v[52:55]
    ds_read_b128 v[96:99], v1 offset:320
    ds_read_b128 v[112:115], v1 offset:128
    ds_read_b128 v[128:131], v1 offset:384
    ds_read_b128 v[192:195], v2 offset:24576
    v_mfma_f32_16x16x32_bf16 v[68:71], v[208:211], v[8:11], 0
    ds_read_b128 v[144:147], v1 offset:192
    ds_read_b128 v[160:163], v1 offset:448
    v_cvt_pk_bf16_f32 v56, v56, v57
    ds_read_b128 v[208:211], v2 offset:28672
    v_mfma_f32_16x16x32_bf16 v[68:71], v[224:227], v[12:15], v[68:71]
    v_cvt_pk_bf16_f32 v57, v58, v59
    v_cvt_pk_bf16_f32 v72, v72, v73
    v_cvt_pk_bf16_f32 v73, v74, v75
    ds_read_b128 v[224:227], v2 offset:25600
    v_mfma_f32_16x16x32_bf16 v[84:87], v[240:243], v[8:11], 0
    v_cvt_pk_bf16_f32 v88, v88, v89
    v_cvt_pk_bf16_f32 v89, v90, v91
    v_cvt_pk_bf16_f32 v104, v104, v105
    ds_read_b128 v[240:243], v2 offset:29696
    s_waitcnt lgkmcnt(15)
    v_mfma_f32_16x16x32_bf16 v[84:87], v[40:43], v[12:15], v[84:87]
    v_cvt_pk_bf16_f32 v105, v106, v107
    v_cvt_pk_bf16_f32 v120, v120, v121
    v_cvt_pk_bf16_f32 v121, v122, v123
    ds_read_b128 v[40:43], v2 offset:26624
    v_mfma_f32_16x16x32_bf16 v[100:103], v[44:47], v[8:11], 0
    v_cvt_pk_bf16_f32 v136, v136, v137
    v_cvt_pk_bf16_f32 v137, v138, v139
    v_cvt_pk_bf16_f32 v152, v152, v153
    ds_read_b128 v[44:47], v2 offset:30720
    s_waitcnt lgkmcnt(11)
    v_mfma_f32_16x16x32_bf16 v[100:103], v[176:179], v[12:15], v[100:103]
    v_cvt_pk_bf16_f32 v153, v154, v155
    v_cvt_pk_bf16_f32 v168, v168, v169
    v_cvt_pk_bf16_f32 v169, v170, v171
    ds_read_b128 v[176:179], v2 offset:27648
    s_waitcnt lgkmcnt(8)
    v_mfma_f32_16x16x32_bf16 v[116:119], v[192:195], v[16:19], 0
    v_cvt_pk_bf16_f32 v184, v184, v185
    v_cvt_pk_bf16_f32 v185, v186, v187
    v_cvt_pk_bf16_f32 v200, v200, v201
    v_mfma_f32_16x16x32_bf16 v[132:135], v[192:195], v[24:27], 0
    v_cvt_pk_bf16_f32 v201, v202, v203
    v_cvt_pk_bf16_f32 v216, v216, v217
    v_cvt_pk_bf16_f32 v217, v218, v219
    v_mfma_f32_16x16x32_bf16 v[148:151], v[192:195], v[32:35], 0
    v_cvt_pk_bf16_f32 v232, v232, v233
    v_cvt_pk_bf16_f32 v233, v234, v235
    v_cvt_pk_bf16_f32 v248, v248, v249
    ds_read_b128 v[192:195], v2 offset:31744
    s_waitcnt lgkmcnt(6)
    v_mfma_f32_16x16x32_bf16 v[116:119], v[208:211], v[20:23], v[116:119]
    v_cvt_pk_bf16_f32 v249, v250, v251
    ds_write_b64 v0, v[56:57] offset:0
    ds_write_b64 v0, v[72:73] offset:528
    v_mfma_f32_16x16x32_bf16 v[132:135], v[208:211], v[28:31], v[132:135]
    ds_write_b64 v0, v[88:89] offset:1056
    ds_write_b64 v0, v[104:105] offset:1584
    ds_write_b64 v0, v[120:121] offset:2112
    v_mfma_f32_16x16x32_bf16 v[148:151], v[208:211], v[36:39], v[148:151]
    ds_write_b64 v0, v[136:137] offset:2640
    ds_write_b64 v0, v[152:153] offset:3168
    ds_write_b64 v0, v[168:169] offset:3696
    ds_read_b128 v[208:211], v2 offset:8192
    s_waitcnt lgkmcnt(14)
    v_mfma_f32_16x16x32_bf16 v[164:167], v[224:227], v[16:19], 0
    ds_write_b64 v0, v[184:185] offset:4224
    ds_write_b64 v0, v[200:201] offset:4752
    ds_write_b64 v0, v[216:217] offset:5280
    v_mfma_f32_16x16x32_bf16 v[180:183], v[224:227], v[24:27], 0
    ds_write_b64 v0, v[232:233] offset:5808
    ds_write_b64 v0, v[248:249] offset:6336
    ds_read_b128 v[104:107], v1 offset:0
    v_mfma_f32_16x16x32_bf16 v[196:199], v[224:227], v[32:35], 0
    ds_read_b128 v[120:123], v1 offset:256
    ds_read_b128 v[136:139], v1 offset:64
    ds_read_b128 v[152:155], v1 offset:320
    ds_read_b128 v[224:227], v2 offset:12288
    s_waitcnt lgkmcnt(15)
    v_mfma_f32_16x16x32_bf16 v[164:167], v[240:243], v[20:23], v[164:167]
    ds_read_b128 v[168:171], v1 offset:128
    ds_read_b128 v[184:187], v1 offset:384
    ds_read_b128 v[200:203], v1 offset:192
    v_mfma_f32_16x16x32_bf16 v[180:183], v[240:243], v[28:31], v[180:183]
    ds_read_b128 v[216:219], v1 offset:448
    v_cvt_pk_bf16_f32 v60, v60, v61
    v_cvt_pk_bf16_f32 v61, v62, v63
    v_mfma_f32_16x16x32_bf16 v[196:199], v[240:243], v[36:39], v[196:199]
    v_cvt_pk_bf16_f32 v76, v76, v77
    v_cvt_pk_bf16_f32 v77, v78, v79
    v_cvt_pk_bf16_f32 v92, v92, v93
    ds_read_b128 v[240:243], v2 offset:9216
    v_mfma_f32_16x16x32_bf16 v[212:215], v[40:43], v[16:19], 0
    v_cvt_pk_bf16_f32 v93, v94, v95
    v_cvt_pk_bf16_f32 v108, v108, v109
    v_cvt_pk_bf16_f32 v109, v110, v111
    v_mfma_f32_16x16x32_bf16 v[228:231], v[40:43], v[24:27], 0
    v_cvt_pk_bf16_f32 v124, v124, v125
    v_cvt_pk_bf16_f32 v125, v126, v127
    v_cvt_pk_bf16_f32 v140, v140, v141
    v_mfma_f32_16x16x32_bf16 v[244:247], v[40:43], v[32:35], 0
    v_cvt_pk_bf16_f32 v141, v142, v143
    v_cvt_pk_bf16_f32 v156, v156, v157
    v_cvt_pk_bf16_f32 v157, v158, v159
    ds_read_b128 v[40:43], v2 offset:13312
    v_mfma_f32_16x16x32_bf16 v[212:215], v[44:47], v[20:23], v[212:215]
    v_cvt_pk_bf16_f32 v172, v172, v173
    v_cvt_pk_bf16_f32 v173, v174, v175
    v_cvt_pk_bf16_f32 v188, v188, v189
    v_mfma_f32_16x16x32_bf16 v[228:231], v[44:47], v[28:31], v[228:231]
    v_cvt_pk_bf16_f32 v189, v190, v191
    v_cvt_pk_bf16_f32 v204, v204, v205
    v_cvt_pk_bf16_f32 v205, v206, v207
    v_mfma_f32_16x16x32_bf16 v[244:247], v[44:47], v[36:39], v[244:247]
    v_cvt_pk_bf16_f32 v220, v220, v221
    v_cvt_pk_bf16_f32 v221, v222, v223
    v_cvt_pk_bf16_f32 v236, v236, v237
    ds_read_b128 v[44:47], v2 offset:10240
    v_mfma_f32_16x16x32_bf16 v[56:59], v[176:179], v[16:19], 0
    v_cvt_pk_bf16_f32 v237, v238, v239
    v_cvt_pk_bf16_f32 v252, v252, v253
    v_cvt_pk_bf16_f32 v253, v254, v255
    v_mfma_f32_16x16x32_bf16 v[72:75], v[176:179], v[24:27], 0
    ds_write_b64 v0, v[60:61] offset:0
    ds_write_b64 v0, v[76:77] offset:528
    ds_write_b64 v0, v[92:93] offset:1056
    v_mfma_f32_16x16x32_bf16 v[88:91], v[176:179], v[32:35], 0
    ds_write_b64 v0, v[108:109] offset:1584
    ds_write_b64 v0, v[124:125] offset:2112
    ds_write_b64 v0, v[140:141] offset:2640
    ds_read_b128 v[176:179], v2 offset:14336
    v_mfma_f32_16x16x32_bf16 v[56:59], v[192:195], v[20:23], v[56:59]
    ds_write_b64 v0, v[156:157] offset:3168
    ds_write_b64 v0, v[172:173] offset:3696
    ds_write_b64 v0, v[188:189] offset:4224
    v_mfma_f32_16x16x32_bf16 v[72:75], v[192:195], v[28:31], v[72:75]
    ds_write_b64 v0, v[204:205] offset:4752
    ds_write_b64 v0, v[220:221] offset:5280
    ds_write_b64 v0, v[236:237] offset:5808
    v_mfma_f32_16x16x32_bf16 v[88:91], v[192:195], v[36:39], v[88:91]
    ds_write_b64 v0, v[252:253] offset:6336
    ds_read_b128 v[60:63], v1 offset:0
    ds_read_b128 v[76:79], v1 offset:256
    ds_read_b128 v[192:195], v2 offset:11264
    ds_read_b128 v[92:95], v1 offset:64
    ds_read_b128 v[108:111], v1 offset:320
    ds_read_b128 v[124:127], v1 offset:128
    ds_read_b128 v[140:143], v1 offset:384
    ds_read_b128 v[156:159], v1 offset:192
    ds_read_b128 v[172:175], v1 offset:448
    s_waitcnt lgkmcnt(15)
    v_mfma_f32_16x16x32_bf16 v[52:55], v[208:211], v[80:83], v[52:55]
    v_cmp_gt_u32 vcc, 98, v4
    s_mul_i32 s24, s2, 98
    v_add_u32 v4, s24, v4
    v_mfma_f32_16x16x32_bf16 v[52:55], v[208:211], v[168:171], v[52:55]
    v_lshlrev_b32 v4, 9, v4
    v_lshl_add_u32 v4, v5, 4, v4
    v_mov_b32 v5, 0x7ffff000
    s_waitcnt lgkmcnt(1)
    v_mfma_f32_16x16x32_bf16 v[52:55], v[208:211], v[156:159], v[52:55]
    v_cndmask_b32 v4, v5, v4, vcc
    s_mov_b32 s24, 0xbfb8aa3b
    v_xor_b32 v144, s26, v144
    ds_read_b128 v[208:211], v2 offset:15360
    v_mfma_f32_16x16x32_bf16 v[52:55], v[224:227], v[96:99], v[52:55]
    v_xor_b32 v145, s26, v145
    v_xor_b32 v146, s26, v146
    v_xor_b32 v147, s26, v147
    v_mfma_f32_16x16x32_bf16 v[52:55], v[224:227], v[184:187], v[52:55]
    v_xor_b32 v160, s26, v160
    v_xor_b32 v161, s26, v161
    v_xor_b32 v162, s26, v162
    s_waitcnt lgkmcnt(1)
    v_mfma_f32_16x16x32_bf16 v[52:55], v[224:227], v[172:175], v[52:55]
    v_xor_b32 v163, s26, v163
    v_xor_b32 v136, s26, v136
    v_xor_b32 v137, s26, v137
    ds_read_b128 v[224:227], v2 offset:16384
    v_mfma_f32_16x16x32_bf16 v[68:71], v[240:243], v[80:83], v[68:71]
    v_xor_b32 v138, s26, v138
    v_xor_b32 v139, s26, v139
    v_xor_b32 v152, s26, v152
    v_mfma_f32_16x16x32_bf16 v[68:71], v[240:243], v[168:171], v[68:71]
    v_xor_b32 v153, s26, v153
    v_xor_b32 v154, s26, v154
    v_xor_b32 v155, s26, v155
    v_mfma_f32_16x16x32_bf16 v[68:71], v[240:243], v[156:159], v[68:71]
    v_xor_b32 v124, s26, v124
    v_xor_b32 v125, s26, v125
    v_xor_b32 v126, s26, v126
    ds_read_b128 v[240:243], v2 offset:20480
    v_mfma_f32_16x16x32_bf16 v[68:71], v[40:43], v[96:99], v[68:71]
    v_xor_b32 v127, s26, v127
    v_xor_b32 v140, s26, v140
    v_xor_b32 v141, s26, v141
    v_mfma_f32_16x16x32_bf16 v[68:71], v[40:43], v[184:187], v[68:71]
    v_xor_b32 v142, s26, v142
    v_xor_b32 v143, s26, v143
    v_mfma_f32_16x16x32_bf16 v[68:71], v[40:43], v[172:175], v[68:71]
    ds_read_b128 v[40:43], v2 offset:32768
    v_mfma_f32_16x16x32_bf16 v[84:87], v[44:47], v[80:83], v[84:87]
    v_mfma_f32_16x16x32_bf16 v[84:87], v[44:47], v[168:171], v[84:87]
    v_mfma_f32_16x16x32_bf16 v[84:87], v[44:47], v[156:159], v[84:87]
    ds_read_b128 v[44:47], v2 offset:36864
    v_mfma_f32_16x16x32_bf16 v[84:87], v[176:179], v[96:99], v[84:87]
    v_mfma_f32_16x16x32_bf16 v[84:87], v[176:179], v[184:187], v[84:87]
    v_mfma_f32_16x16x32_bf16 v[84:87], v[176:179], v[172:175], v[84:87]
    ds_read_b128 v[176:179], v2 offset:17408
    v_mfma_f32_16x16x32_bf16 v[100:103], v[192:195], v[80:83], v[100:103]
    v_mfma_f32_16x16x32_bf16 v[100:103], v[192:195], v[168:171], v[100:103]
    v_mfma_f32_16x16x32_bf16 v[100:103], v[192:195], v[156:159], v[100:103]
    ds_read_b128 v[192:195], v2 offset:21504
    s_waitcnt lgkmcnt(6)
    v_mfma_f32_16x16x32_bf16 v[100:103], v[208:211], v[96:99], v[100:103]
    v_mfma_f32_16x16x32_bf16 v[100:103], v[208:211], v[184:187], v[100:103]
    v_mfma_f32_16x16x32_bf16 v[100:103], v[208:211], v[172:175], v[100:103]
    ds_read_b128 v[208:211], v2 offset:33792
    s_waitcnt lgkmcnt(6)
    v_mfma_f32_16x16x32_bf16 v[116:119], v[224:227], v[48:51], v[116:119]
    v_mfma_f32_16x16x32_bf16 v[132:135], v[224:227], v[104:107], v[132:135]
    v_mfma_f32_16x16x32_bf16 v[148:151], v[224:227], v[60:63], v[148:151]
    ds_read_b128 v[224:227], v2 offset:37888
    s_waitcnt lgkmcnt(6)
    v_mfma_f32_16x16x32_bf16 v[116:119], v[240:243], v[64:67], v[116:119]
    v_mfma_f32_16x16x32_bf16 v[132:135], v[240:243], v[120:123], v[132:135]
    v_mfma_f32_16x16x32_bf16 v[148:151], v[240:243], v[76:79], v[148:151]
    ds_read_b128 v[240:243], v2 offset:18432
    s_waitcnt lgkmcnt(6)
    v_mfma_f32_16x16x32_bf16 v[148:151], v[40:43], v[112:115], v[148:151]
    v_mfma_f32_16x16x32_bf16 v[132:135], v[40:43], v[144:147], v[132:135]
    v_mfma_f32_16x16x32_bf16 v[148:151], v[40:43], v[136:139], v[148:151]
    v_mfma_f32_16x16x32_bf16 v[116:119], v[40:43], v[200:203], v[116:119]
    v_mfma_f32_16x16x32_bf16 v[132:135], v[40:43], v[92:95], v[132:135]
    v_mfma_f32_16x16x32_bf16 v[116:119], v[40:43], v[124:127], v[116:119]
    ds_read_b128 v[40:43], v2 offset:22528
    s_waitcnt lgkmcnt(6)
    v_mfma_f32_16x16x32_bf16 v[148:151], v[44:47], v[128:131], v[148:151]
    v_mfma_f32_16x16x32_bf16 v[132:135], v[44:47], v[160:163], v[132:135]
    v_mfma_f32_16x16x32_bf16 v[148:151], v[44:47], v[152:155], v[148:151]
    v_mfma_f32_16x16x32_bf16 v[116:119], v[44:47], v[216:219], v[116:119]
    v_mfma_f32_16x16x32_bf16 v[132:135], v[44:47], v[108:111], v[132:135]
    v_mfma_f32_16x16x32_bf16 v[116:119], v[44:47], v[140:143], v[116:119]
    ds_read_b128 v[44:47], v2 offset:34816
    s_waitcnt lgkmcnt(6)
    v_mfma_f32_16x16x32_bf16 v[164:167], v[176:179], v[48:51], v[164:167]
    v_mfma_f32_16x16x32_bf16 v[180:183], v[176:179], v[104:107], v[180:183]
    v_mfma_f32_16x16x32_bf16 v[196:199], v[176:179], v[60:63], v[196:199]
    ds_read_b128 v[176:179], v2 offset:38912
    s_waitcnt lgkmcnt(6)
    v_mfma_f32_16x16x32_bf16 v[164:167], v[192:195], v[64:67], v[164:167]
    v_mfma_f32_16x16x32_bf16 v[180:183], v[192:195], v[120:123], v[180:183]
    v_mfma_f32_16x16x32_bf16 v[196:199], v[192:195], v[76:79], v[196:199]
    ds_read_b128 v[192:195], v2 offset:19456
    s_waitcnt lgkmcnt(6)
    v_mfma_f32_16x16x32_bf16 v[196:199], v[208:211], v[112:115], v[196:199]
    v_mfma_f32_16x16x32_bf16 v[180:183], v[208:211], v[144:147], v[180:183]
    v_mfma_f32_16x16x32_bf16 v[196:199], v[208:211], v[136:139], v[196:199]
    v_mfma_f32_16x16x32_bf16 v[164:167], v[208:211], v[200:203], v[164:167]
    v_mfma_f32_16x16x32_bf16 v[180:183], v[208:211], v[92:95], v[180:183]
    v_mfma_f32_16x16x32_bf16 v[164:167], v[208:211], v[124:127], v[164:167]
    ds_read_b128 v[208:211], v2 offset:23552
    s_waitcnt lgkmcnt(6)
    v_mfma_f32_16x16x32_bf16 v[196:199], v[224:227], v[128:131], v[196:199]
    v_mfma_f32_16x16x32_bf16 v[180:183], v[224:227], v[160:163], v[180:183]
    v_mfma_f32_16x16x32_bf16 v[196:199], v[224:227], v[152:155], v[196:199]
    v_mfma_f32_16x16x32_bf16 v[164:167], v[224:227], v[216:219], v[164:167]
    v_mfma_f32_16x16x32_bf16 v[180:183], v[224:227], v[108:111], v[180:183]
    v_mfma_f32_16x16x32_bf16 v[164:167], v[224:227], v[140:143], v[164:167]
    ds_read_b128 v[224:227], v2 offset:35840
    s_waitcnt lgkmcnt(6)
    v_mfma_f32_16x16x32_bf16 v[212:215], v[240:243], v[48:51], v[212:215]
    v_mfma_f32_16x16x32_bf16 v[228:231], v[240:243], v[104:107], v[228:231]
    v_mfma_f32_16x16x32_bf16 v[244:247], v[240:243], v[60:63], v[244:247]
    ds_read_b128 v[240:243], v2 offset:39936
    s_waitcnt lgkmcnt(6)
    v_mfma_f32_16x16x32_bf16 v[212:215], v[40:43], v[64:67], v[212:215]
    v_mfma_f32_16x16x32_bf16 v[228:231], v[40:43], v[120:123], v[228:231]
    v_mfma_f32_16x16x32_bf16 v[244:247], v[40:43], v[76:79], v[244:247]
    s_waitcnt lgkmcnt(5)
    v_mfma_f32_16x16x32_bf16 v[244:247], v[44:47], v[112:115], v[244:247]
    v_mfma_f32_16x16x32_bf16 v[228:231], v[44:47], v[144:147], v[228:231]
    v_mfma_f32_16x16x32_bf16 v[244:247], v[44:47], v[136:139], v[244:247]
    v_mfma_f32_16x16x32_bf16 v[212:215], v[44:47], v[200:203], v[212:215]
    v_mfma_f32_16x16x32_bf16 v[228:231], v[44:47], v[92:95], v[228:231]
    v_mfma_f32_16x16x32_bf16 v[212:215], v[44:47], v[124:127], v[212:215]
    s_waitcnt lgkmcnt(4)
    v_mfma_f32_16x16x32_bf16 v[244:247], v[176:179], v[128:131], v[244:247]
    v_mfma_f32_16x16x32_bf16 v[228:231], v[176:179], v[160:163], v[228:231]
    v_mfma_f32_16x16x32_bf16 v[244:247], v[176:179], v[152:155], v[244:247]
    v_mfma_f32_16x16x32_bf16 v[212:215], v[176:179], v[216:219], v[212:215]
    v_mfma_f32_16x16x32_bf16 v[228:231], v[176:179], v[108:111], v[228:231]
    v_mfma_f32_16x16x32_bf16 v[212:215], v[176:179], v[140:143], v[212:215]
    s_waitcnt lgkmcnt(3)
    v_mfma_f32_16x16x32_bf16 v[56:59], v[192:195], v[48:51], v[56:59]
    v_mfma_f32_16x16x32_bf16 v[72:75], v[192:195], v[104:107], v[72:75]
    v_mfma_f32_16x16x32_bf16 v[88:91], v[192:195], v[60:63], v[88:91]
    s_waitcnt lgkmcnt(2)
    v_mfma_f32_16x16x32_bf16 v[56:59], v[208:211], v[64:67], v[56:59]
    v_mfma_f32_16x16x32_bf16 v[72:75], v[208:211], v[120:123], v[72:75]
    v_mfma_f32_16x16x32_bf16 v[88:91], v[208:211], v[76:79], v[88:91]
    s_waitcnt lgkmcnt(1)
    v_mfma_f32_16x16x32_bf16 v[88:91], v[224:227], v[112:115], v[88:91]
    v_mfma_f32_16x16x32_bf16 v[72:75], v[224:227], v[144:147], v[72:75]
    v_mfma_f32_16x16x32_bf16 v[88:91], v[224:227], v[136:139], v[88:91]
    v_mfma_f32_16x16x32_bf16 v[56:59], v[224:227], v[200:203], v[56:59]
    v_mfma_f32_16x16x32_bf16 v[72:75], v[224:227], v[92:95], v[72:75]
    v_mfma_f32_16x16x32_bf16 v[56:59], v[224:227], v[124:127], v[56:59]
    s_waitcnt lgkmcnt(0)
    v_mfma_f32_16x16x32_bf16 v[88:91], v[240:243], v[128:131], v[88:91]
    v_mfma_f32_16x16x32_bf16 v[72:75], v[240:243], v[160:163], v[72:75]
    v_mfma_f32_16x16x32_bf16 v[88:91], v[240:243], v[152:155], v[88:91]
    v_mfma_f32_16x16x32_bf16 v[56:59], v[240:243], v[216:219], v[56:59]
    v_mfma_f32_16x16x32_bf16 v[72:75], v[240:243], v[108:111], v[72:75]
    v_mfma_f32_16x16x32_bf16 v[56:59], v[240:243], v[140:143], v[56:59]
    s_nop 7
    v_lshlrev_b32 v0, 1, v4
    v_cndmask_b32 v0, v5, v0, vcc
    s_cmp_eq_u32 s19, 0
    s_cbranch_scc1 M_noload
    buffer_load_dwordx4 v[8:11], v0, s[92:95], 0 offen offset:0 sc1
    buffer_load_dwordx4 v[12:15], v0, s[92:95], 0 offen offset:16 sc1
    buffer_load_dwordx4 v[16:19], v0, s[92:95], 0 offen offset:128 sc1
    buffer_load_dwordx4 v[20:23], v0, s[92:95], 0 offen offset:144 sc1
    s_waitcnt vmcnt(0)
    v_add_f32 v52, v52, v8
    v_add_f32 v53, v53, v9
    v_add_f32 v54, v54, v10
    v_add_f32 v55, v55, v11
    v_add_f32 v68, v68, v12
    v_add_f32 v69, v69, v13
    v_add_f32 v70, v70, v14
    v_add_f32 v71, v71, v15
    v_add_f32 v84, v84, v16
    v_add_f32 v85, v85, v17
    v_add_f32 v86, v86, v18
    v_add_f32 v87, v87, v19
    v_add_f32 v100, v100, v20
    v_add_f32 v101, v101, v21
    v_add_f32 v102, v102, v22
    v_add_f32 v103, v103, v23
    buffer_load_dwordx4 v[8:11], v0, s[92:95], 0 offen offset:256 sc1
    buffer_load_dwordx4 v[12:15], v0, s[92:95], 0 offen offset:272 sc1
    buffer_load_dwordx4 v[16:19], v0, s[92:95], 0 offen offset:384 sc1
    buffer_load_dwordx4 v[20:23], v0, s[92:95], 0 offen offset:400 sc1
    s_waitcnt vmcnt(0)
    v_add_f32 v116, v116, v8
    v_add_f32 v117, v117, v9
    v_add_f32 v118, v118, v10
    v_add_f32 v119, v119, v11
    v_add_f32 v164, v164, v12
    v_add_f32 v165, v165, v13
    v_add_f32 v166, v166, v14
    v_add_f32 v167, v167, v15
    v_add_f32 v212, v212, v16
    v_add_f32 v213, v213, v17
    v_add_f32 v214, v214, v18
    v_add_f32 v215, v215, v19
    v_add_f32 v56, v56, v20
    v_add_f32 v57, v57, v21
    v_add_f32 v58, v58, v22
    v_add_f32 v59, v59, v23
    buffer_load_dwordx4 v[8:11], v0, s[92:95], 0 offen offset:512 sc1
    buffer_load_dwordx4 v[12:15], v0, s[92:95], 0 offen offset:528 sc1
    buffer_load_dwordx4 v[16:19], v0, s[92:95], 0 offen offset:640 sc1
    buffer_load_dwordx4 v[20:23], v0, s[92:95], 0 offen offset:656 sc1
    s_waitcnt vmcnt(0)
    v_add_f32 v132, v132, v8
    v_add_f32 v133, v133, v9
    v_add_f32 v134, v134, v10
    v_add_f32 v135, v135, v11
    v_add_f32 v180, v180, v12
    v_add_f32 v181, v181, v13
    v_add_f32 v182, v182, v14
    v_add_f32 v183, v183, v15
    v_add_f32 v228, v228, v16
    v_add_f32 v229, v229, v17
    v_add_f32 v230, v230, v18
    v_add_f32 v231, v231, v19
    v_add_f32 v72, v72, v20
    v_add_f32 v73, v73, v21
    v_add_f32 v74, v74, v22
    v_add_f32 v75, v75, v23
    buffer_load_dwordx4 v[8:11], v0, s[92:95], 0 offen offset:768 sc1
    buffer_load_dwordx4 v[12:15], v0, s[92:95], 0 offen offset:784 sc1
    buffer_load_dwordx4 v[16:19], v0, s[92:95], 0 offen offset:896 sc1
    buffer_load_dwordx4 v[20:23], v0, s[92:95], 0 offen offset:912 sc1
    s_waitcnt vmcnt(0)
    v_add_f32 v148, v148, v8
    v_add_f32 v149, v149, v9
    v_add_f32 v150, v150, v10
    v_add_f32 v151, v151, v11
    v_add_f32 v196, v196, v12
    v_add_f32 v197, v197, v13
    v_add_f32 v198, v198, v14
    v_add_f32 v199, v199, v15
    v_add_f32 v244, v244, v16
    v_add_f32 v245, v245, v17
    v_add_f32 v246, v246, v18
    v_add_f32 v247, v247, v19
    v_add_f32 v88, v88, v20
    v_add_f32 v89, v89, v21
    v_add_f32 v90, v90, v22
    v_add_f32 v91, v91, v23
M_noload:
    s_cmp_eq_u32 s21, 0
    s_cbranch_scc1 M_final
    buffer_store_dwordx4 v[52:55], v0, s[92:95], 0 offen offset:0 sc1
    buffer_store_dwordx4 v[68:71], v0, s[92:95], 0 offen offset:16 sc1
    buffer_store_dwordx4 v[84:87], v0, s[92:95], 0 offen offset:128 sc1
    buffer_store_dwordx4 v[100:103], v0, s[92:95], 0 offen offset:144 sc1
    buffer_store_dwordx4 v[116:119], v0, s[92:95], 0 offen offset:256 sc1
    buffer_store_dwordx4 v[164:167], v0, s[92:95], 0 offen offset:272 sc1
    buffer_store_dwordx4 v[212:215], v0, s[92:95], 0 offen offset:384 sc1
    buffer_store_dwordx4 v[56:59], v0, s[92:95], 0 offen offset:400 sc1
    buffer_store_dwordx4 v[132:135], v0, s[92:95], 0 offen offset:512 sc1
    buffer_store_dwordx4 v[180:183], v0, s[92:95], 0 offen offset:528 sc1
    buffer_store_dwordx4 v[228:231], v0, s[92:95], 0 offen offset:640 sc1
    buffer_store_dwordx4 v[72:75], v0, s[92:95], 0 offen offset:656 sc1
    buffer_store_dwordx4 v[148:151], v0, s[92:95], 0 offen offset:768 sc1
    buffer_store_dwordx4 v[196:199], v0, s[92:95], 0 offen offset:784 sc1
    buffer_store_dwordx4 v[244:247], v0, s[92:95], 0 offen offset:896 sc1
    buffer_store_dwordx4 v[88:91], v0, s[92:95], 0 offen offset:912 sc1
    s_add_u32 s19, s19, s20
    s_waitcnt vmcnt(0) lgkmcnt(0)
    s_barrier
    s_branch M_round
M_final:
    v_mul_f32 v188, s24, v52
    v_mul_f32 v189, s24, v53
    v_mul_f32 v190, s24, v54
    v_mul_f32 v191, s24, v55
    v_mul_f32 v204, s24, v68
    v_mul_f32 v205, s24, v69
    v_mul_f32 v206, s24, v70
    v_mul_f32 v207, s24, v71
    v_mul_f32 v220, s24, v84
    v_mul_f32 v221, s24, v85
    v_mul_f32 v222, s24, v86
    v_mul_f32 v223, s24, v87
    v_mul_f32 v236, s24, v100
    v_mul_f32 v237, s24, v101
    v_mul_f32 v238, s24, v102
    v_mul_f32 v239, s24, v103
    v_exp_f32 v188, v188
    v_exp_f32 v189, v189
    v_exp_f32 v190, v190
    v_exp_f32 v191, v191
    v_exp_f32 v204, v204
    v_exp_f32 v205, v205
    v_exp_f32 v206, v206
    v_exp_f32 v207, v207
    v_exp_f32 v220, v220
    v_exp_f32 v221, v221
    v_exp_f32 v222, v222
    v_exp_f32 v223, v223
    v_exp_f32 v236, v236
    v_exp_f32 v237, v237
    v_exp_f32 v238, v238
    v_exp_f32 v239, v239
    v_add_f32 v188, 1.0, v188
    v_add_f32 v189, 1.0, v189
    v_add_f32 v190, 1.0, v190
    v_add_f32 v191, 1.0, v191
    v_add_f32 v204, 1.0, v204
    v_add_f32 v205, 1.0, v205
    v_add_f32 v206, 1.0, v206
    v_add_f32 v207, 1.0, v207
    v_add_f32 v220, 1.0, v220
    v_add_f32 v221, 1.0, v221
    v_add_f32 v222, 1.0, v222
    v_add_f32 v223, 1.0, v223
    v_add_f32 v236, 1.0, v236
    v_add_f32 v237, 1.0, v237
    v_add_f32 v238, 1.0, v238
    v_add_f32 v239, 1.0, v239
    v_rcp_f32 v188, v188
    v_rcp_f32 v189, v189
    v_rcp_f32 v190, v190
    v_rcp_f32 v191, v191
    v_rcp_f32 v204, v204
    v_rcp_f32 v205, v205
    v_rcp_f32 v206, v206
    v_rcp_f32 v207, v207
    v_rcp_f32 v220, v220
    v_rcp_f32 v221, v221
    v_rcp_f32 v222, v222
    v_rcp_f32 v223, v223
    v_rcp_f32 v236, v236
    v_rcp_f32 v237, v237
    v_rcp_f32 v238, v238
    v_rcp_f32 v239, v239
    v_cvt_pk_bf16_f32 v8, v52, v53
    v_cvt_pk_bf16_f32 v9, v54, v55
    v_cvt_pk_bf16_f32 v10, v68, v69
    v_cvt_pk_bf16_f32 v11, v70, v71
    buffer_store_dwordx4 v[8:11], v4, s[12:15], 0 offen offset:0 nt
    v_cvt_pk_bf16_f32 v12, v84, v85
    v_cvt_pk_bf16_f32 v13, v86, v87
    v_cvt_pk_bf16_f32 v14, v100, v101
    v_cvt_pk_bf16_f32 v15, v102, v103
    buffer_store_dwordx4 v[12:15], v4, s[12:15], 0 offen offset:64 nt
    v_pk_mul_f32 v[116:117], v[116:117], v[188:189]
    v_pk_mul_f32 v[118:119], v[118:119], v[190:191]
    v_pk_mul_f32 v[164:165], v[164:165], v[204:205]
    v_pk_mul_f32 v[166:167], v[166:167], v[206:207]
    v_cvt_pk_bf16_f32 v16, v116, v117
    v_cvt_pk_bf16_f32 v17, v118, v119
    v_cvt_pk_bf16_f32 v18, v164, v165
    v_cvt_pk_bf16_f32 v19, v166, v167
    buffer_store_dwordx4 v[16:19], v4, s[12:15], 0 offen offset:128 nt
    v_pk_mul_f32 v[212:213], v[212:213], v[220:221]
    v_pk_mul_f32 v[214:215], v[214:215], v[222:223]
    v_pk_mul_f32 v[56:57], v[56:57], v[236:237]
    v_pk_mul_f32 v[58:59], v[58:59], v[238:239]
    v_cvt_pk_bf16_f32 v20, v212, v213
    v_cvt_pk_bf16_f32 v21, v214, v215
    v_cvt_pk_bf16_f32 v22, v56, v57
    v_cvt_pk_bf16_f32 v23, v58, v59
    buffer_store_dwordx4 v[20:23], v4, s[12:15], 0 offen offset:192 nt
    v_pk_mul_f32 v[132:133], v[132:133], v[188:189]
    v_pk_mul_f32 v[134:135], v[134:135], v[190:191]
    v_pk_mul_f32 v[180:181], v[180:181], v[204:205]
    v_pk_mul_f32 v[182:183], v[182:183], v[206:207]
    v_cvt_pk_bf16_f32 v24, v132, v133
    v_cvt_pk_bf16_f32 v25, v134, v135
    v_cvt_pk_bf16_f32 v26, v180, v181
    v_cvt_pk_bf16_f32 v27, v182, v183
    buffer_store_dwordx4 v[24:27], v4, s[12:15], 0 offen offset:256 nt
    v_pk_mul_f32 v[228:229], v[228:229], v[220:221]
    v_pk_mul_f32 v[230:231], v[230:231], v[222:223]
    v_pk_mul_f32 v[72:73], v[72:73], v[236:237]
    v_pk_mul_f32 v[74:75], v[74:75], v[238:239]
    v_cvt_pk_bf16_f32 v28, v228, v229
    v_cvt_pk_bf16_f32 v29, v230, v231
    v_cvt_pk_bf16_f32 v30, v72, v73
    v_cvt_pk_bf16_f32 v31, v74, v75
    buffer_store_dwordx4 v[28:31], v4, s[12:15], 0 offen offset:320 nt
    v_pk_mul_f32 v[148:149], v[148:149], v[188:189]
    v_pk_mul_f32 v[150:151], v[150:151], v[190:191]
    v_pk_mul_f32 v[196:197], v[196:197], v[204:205]
    v_pk_mul_f32 v[198:199], v[198:199], v[206:207]
    v_cvt_pk_bf16_f32 v32, v148, v149
    v_cvt_pk_bf16_f32 v33, v150, v151
    v_cvt_pk_bf16_f32 v34, v196, v197
    v_cvt_pk_bf16_f32 v35, v198, v199
    buffer_store_dwordx4 v[32:35], v4, s[12:15], 0 offen offset:384 nt
    v_pk_mul_f32 v[244:245], v[244:245], v[220:221]
    v_pk_mul_f32 v[246:247], v[246:247], v[222:223]
    v_pk_mul_f32 v[88:89], v[88:89], v[236:237]
    v_pk_mul_f32 v[90:91], v[90:91], v[238:239]
    v_cvt_pk_bf16_f32 v36, v244, v245
    v_cvt_pk_bf16_f32 v37, v246, v247
    v_cvt_pk_bf16_f32 v38, v88, v89
    v_cvt_pk_bf16_f32 v39, v90, v91
    buffer_store_dwordx4 v[36:39], v4, s[12:15], 0 offen offset:448 nt
M_end:
M_done:
    s_endpgm
.section .rodata,"a"

.p2align 6
.amdhsa_kernel part_kernel
  .amdhsa_next_free_vgpr 88
  .amdhsa_next_free_sgpr 32
  .amdhsa_accum_offset 88
  .amdhsa_group_segment_fixed_size 0
  .amdhsa_kernarg_size 96
  .amdhsa_user_sgpr_count 2
  .amdhsa_user_sgpr_kernarg_segment_ptr 1
  .amdhsa_system_sgpr_workgroup_id_x 1
  .amdhsa_float_denorm_mode_32 3
.end_amdhsa_kernel

.p2align 6
.amdhsa_kernel main_kernel
  .amdhsa_next_free_vgpr 256
  .amdhsa_next_free_sgpr 102
  .amdhsa_accum_offset 256
  .amdhsa_group_segment_fixed_size 0
  .amdhsa_kernarg_size 96
  .amdhsa_user_sgpr_count 2
  .amdhsa_user_sgpr_kernarg_segment_ptr 1
  .amdhsa_system_sgpr_workgroup_id_x 1
  .amdhsa_float_denorm_mode_32 3
.end_amdhsa_kernel
```
